```python
import torch

def _softmax(x, axis=-1):
    return torch.softmax(x, dim=axis)
def _gelu(x):
    return torch.nn.functional.gelu(x, approximate="tanh")
def _silu(x):
    return torch.nn.functional.silu(x)
def _sigmoid(x):
    return torch.sigmoid(x)
def _layernorm(x, axis=-1, eps=1e-5):
    m = x.mean(dim=axis, keepdim=True)
    v = x.var(dim=axis, keepdim=True, unbiased=False)
    return (x - m) / torch.sqrt(v + eps)
def _scatter_add(tgt, idx, src, axis=0):
    return tgt.clone().index_add_(axis, idx, src)
def _segment_sum(src, seg, n):
    out = torch.zeros((n,) + src.shape[1:], dtype=src.dtype)
    return out.index_add_(0, seg, src)
def _pad(x, pw):
    flat = tuple(v for pair in reversed(pw) for v in pair)
    return torch.nn.functional.pad(x, flat)

kernel_name = 'concat_heads__mha_block_cached__mha_block_cached__near_ridge'

def setup_inputs():

    _w = (lambda a: (lambda t: t.to(torch.bfloat16) if t.is_floating_point() else t)(torch.as_tensor(a)))
    def _A_setup():
        B, Sq, D = 16, 80, 512
        H, Sk, Dh = 32, 80, 128
        return {
            "x": _w((lambda *s: torch.randn(*s, dtype=torch.bfloat16) * 0.8)(B, Sq, D)),
            "k_cache": _w((lambda *s: torch.randn(*s, dtype=torch.bfloat16) * 0.8)(B, H, Sk, Dh)),
            "v_cache": _w((lambda *s: torch.randn(*s, dtype=torch.bfloat16) * 0.05)(B, H, Sk, Dh)),
            "wq": _w((lambda *s: torch.randn(*s, dtype=torch.bfloat16) * 0.8)(D, H * Dh) * (D ** -0.5)),
            "wo": _w((lambda *s: torch.randn(*s, dtype=torch.bfloat16) * 0.05)(H * Dh, D) * ((H * Dh) ** -0.5)),
        }
    _A_in = _A_setup()

    def _B_setup():
        B, Sq, D = 16, 80, 512
        H, Sk, Dh = 32, 80, 128
        return {
            "x": _w((lambda *s: torch.randn(*s, dtype=torch.bfloat16) * 0.8)(B, Sq, D)),
            "k_cache": _w((lambda *s: torch.randn(*s, dtype=torch.bfloat16) * 0.8)(B, H, Sk, Dh)),
            "v_cache": _w((lambda *s: torch.randn(*s, dtype=torch.bfloat16) * 0.05)(B, H, Sk, Dh)),
            "wq": _w((lambda *s: torch.randn(*s, dtype=torch.bfloat16) * 0.8)(D, H * Dh) * (D ** -0.5)),
            "wo": _w((lambda *s: torch.randn(*s, dtype=torch.bfloat16) * 0.05)(H * Dh, D) * ((H * Dh) ** -0.5)),
        }
    _B_in = _B_setup()

    return {
        "A_x": _A_in["x"],
        "A_k_cache": _A_in["k_cache"],
        "A_v_cache": _A_in["v_cache"],
        "A_wq": _A_in["wq"],
        "A_wo": _A_in["wo"],
        "B_x": _B_in["x"],
        "B_k_cache": _B_in["k_cache"],
        "B_v_cache": _B_in["v_cache"],
        "B_wq": _B_in["wq"],
        "B_wo": _B_in["wo"],
    }

def reference(A_x, A_k_cache, A_v_cache, A_wq, A_wo, B_x, B_k_cache, B_v_cache, B_wq, B_wo):
    def _A_ref(x, k_cache, v_cache, wq, wo):
        B, Sq, D = x.shape
        H, Dh = 32, 128
        q = (lambda x, *d: x.permute(*d))((x @ wq).reshape(B, Sq, H, Dh), 0, 2, 1, 3)
        scores = torch.einsum("bhqd,bhkd->bhqk", q, k_cache) * (Dh ** -0.5)
        p = _softmax(scores, axis=-1)
        o = torch.einsum("bhqk,bhkd->bhqd", p, v_cache)
        return (lambda x, *d: x.permute(*d))(o, 0, 2, 1, 3).reshape(B, Sq, H * Dh) @ wo

    def _B_ref(x, k_cache, v_cache, wq, wo):
        B, Sq, D = x.shape
        H, Dh = 32, 128
        q = (lambda x, *d: x.permute(*d))((x @ wq).reshape(B, Sq, H, Dh), 0, 2, 1, 3)
        scores = torch.einsum("bhqd,bhkd->bhqk", q, k_cache) * (Dh ** -0.5)
        p = _softmax(scores, axis=-1)
        o = torch.einsum("bhqk,bhkd->bhqd", p, v_cache)
        return (lambda x, *d: x.permute(*d))(o, 0, 2, 1, 3).reshape(B, Sq, H * Dh) @ wo

    a = _A_ref(A_x, A_k_cache, A_v_cache, A_wq, A_wo)
    b = _B_ref(B_x, B_k_cache, B_v_cache, B_wq, B_wo)
    return torch.concatenate([a, b], axis=-1)
```

```asm
; @launch grid=(256,1,1) block=(256,1,1) lds=163840
.amdgcn_target "amdgcn-amd-amdhsa--gfx950"
.text
.globl concat_heads__mha_block_cached__mha_block_cached__near_ridge_kernel
.p2align 8
.type concat_heads__mha_block_cached__mha_block_cached__near_ridge_kernel,@function
concat_heads__mha_block_cached__mha_block_cached__near_ridge_kernel:
    s_cmp_ge_u32 s2, 256
    s_cbranch_scc1 L_end
    s_bfe_u32 s57, s2, 0x10002
    s_load_dwordx4 s[48:51], s[0:1], 80
    s_load_dwordx2 s[52:53], s[0:1], 96
    s_mul_i32 s3, s57, 40
    s_add_u32 s0, s0, s3
    s_addc_u32 s1, s1, 0
    s_load_dwordx8 s[36:43], s[0:1], 0
    s_load_dwordx2 s[44:45], s[0:1], 32
    s_getpc_b64 s[46:47]
L_cpf0_pc:
    s_lshr_b32 s3, s2, 3
    s_mul_i32 s3, s3, 1152
    s_add_u32 s3, s3, 0
    v_lshlrev_b32 v16, 7, v0
    v_add_u32 v16, s3, v16
    v_min_u32 v16, L_end-concat_heads__mha_block_cached__mha_block_cached__near_ridge_kernel, v16
    s_sub_u32 s46, s46, L_cpf0_pc-concat_heads__mha_block_cached__mha_block_cached__near_ridge_kernel
    s_subb_u32 s47, s47, 0
    v_mov_b32 v17, s47
    v_add_co_u32 v16, vcc, s46, v16
    s_nop 1
    v_addc_co_u32 v17, vcc, 0, v17, vcc
    v_cmp_gt_u32 vcc, 9, v0
    s_nop 1
    s_and_saveexec_b64 s[46:47], vcc
    s_cbranch_execz L_cpf0
    global_load_dword v255, v[16:17], off
L_cpf0:
    s_mov_b64 exec, -1
    v_lshrrev_b32 v244, 6, v0
    v_and_b32 v1, 63, v0
    s_and_b32 s3, s2, 3
    s_lshl_b32 s3, s3, 1
    s_bfe_u32 s56, s2, 0x10003
    s_or_b32 s56, s56, s3
    v_readfirstlane_b32 s54, v244
    s_lshr_b32 s55, s2, 4
    s_lshl_b32 s58, s57, 4
    s_add_u32 s58, s58, s55
    v_lshrrev_b32 v2, 4, v1
    v_and_b32 v3, 15, v1
    v_lshrrev_b32 v244, 3, v1
    v_and_b32 v245, 6, v244
    v_and_b32 v18, 7, v1
    v_xor_b32 v18, v18, v245
    v_lshlrev_b32 v18, 4, v18
    v_lshl_add_u32 v18, v244, 10, v18
    s_and_b32 s3, s54, 1
    s_lshr_b32 s71, s54, 1
    s_mov_b32 s63, s55
    s_lshl_b32 s72, s3, 13
    s_and_b32 s63, s63, 7
    s_lshl_b32 s61, s63, 1
    s_add_u32 s63, s63, s71
    s_lshr_b32 s65, s55, 3
    s_sub_u32 s62, s61, s65
    s_add_u32 s61, s61, s65
    s_lshl_b32 s61, s61, 18
    s_lshl_b32 s62, s62, 18
    v_add_u32 v18, s72, v18
    s_mul_i32 s76, s71, 40960
    s_lshl_b32 s3, s3, 10
    s_add_u32 s76, s76, s3
    s_mul_i32 s59, s54, 40960
    v_and_b32 v245, 1, v2
    v_lshlrev_b32 v245, 1, v245
    v_and_b32 v4, 7, v1
    v_xor_b32 v4, v4, v245
    v_lshlrev_b32 v4, 4, v4
    v_lshl_add_u32 v4, v244, 13, v4
    v_xor_b32 v5, 64, v4
    v_add_u32 v5, 0x10000, v5
    v_add_u32 v6, 0x20000, v4
    v_add_u32 v7, 0x20000, v5
    s_lshl_b32 s78, s56, 2
    s_add_u32 s78, s78, s54
    v_lshrrev_b32 v252, 1, v1
    v_and_b32 v245, 1, v1
    v_lshlrev_b32 v252, 13, v252
    v_lshl_add_u32 v252, v245, 7, v252
    s_waitcnt lgkmcnt(0)
    s_mul_i32 s3, s55, 81920
    s_add_u32 s4, s36, s3
    s_addc_u32 s5, s37, 0
    s_mov_b32 s6, 81920
    s_mov_b32 s7, 0x20000
    s_lshl_b32 s3, s78, 8
    s_add_u32 s16, s42, s3
    s_addc_u32 s17, s43, 0
    s_mov_b32 s18, 4186368
    s_mov_b32 s19, 0x20000
    s_add_u32 s64, s63, 0
    s_and_b32 s64, s64, 7
    s_lshl_b32 s64, s64, 7
    s_add_u32 m0, s76, 0
    s_add_u32 s65, s64, 0
    buffer_load_dwordx4 v18, s[4:7], s65 offen lds
    s_add_u32 m0, s76, 2048
    s_add_u32 s65, s64, 16384
    buffer_load_dwordx4 v18, s[4:7], s65 offen lds
    s_add_u32 m0, s76, 4096
    s_add_u32 s65, s64, 32768
    buffer_load_dwordx4 v18, s[4:7], s65 offen lds
    s_add_u32 m0, s76, 6144
    s_add_u32 s65, s64, 49152
    buffer_load_dwordx4 v18, s[4:7], s65 offen lds
    s_add_u32 m0, s76, 8192
    s_add_u32 s65, s64, 65536
    buffer_load_dwordx4 v18, s[4:7], s65 offen lds
    s_add_u32 s60, s61, 0
    s_and_b32 s60, s60, 0x3fffff
    s_add_u32 m0, s59, 12288
    s_nop 0
    buffer_load_dwordx4 v4, s[16:19], s60 offen lds
    s_add_u32 m0, s59, 13312
    s_nop 0
    buffer_load_dwordx4 v5, s[16:19], s60 offen lds
    s_add_u32 m0, s59, 14336
    s_nop 0
    buffer_load_dwordx4 v6, s[16:19], s60 offen lds
    s_add_u32 m0, s59, 15360
    s_nop 0
    buffer_load_dwordx4 v7, s[16:19], s60 offen lds
    s_lshl_b32 s3, s55, 5
    s_add_u32 s3, s3, s78
    s_mul_i32 s3, s3, 20480
    s_add_u32 s8, s38, s3
    s_addc_u32 s9, s39, 0
    s_mov_b32 s10, 20480
    s_mov_b32 s11, 0x20000
    s_add_u32 s12, s40, s3
    s_addc_u32 s13, s41, 0
    s_mov_b32 s14, 20480
    s_mov_b32 s15, 0x20000
    s_barrier
    s_add_u32 s60, s60, 128
    s_add_u32 m0, s59, 16384
    s_nop 0
    buffer_load_dwordx4 v4, s[16:19], s60 offen lds
    s_add_u32 m0, s59, 17408
    s_nop 0
    buffer_load_dwordx4 v5, s[16:19], s60 offen lds
    s_add_u32 m0, s59, 18432
    s_nop 0
    buffer_load_dwordx4 v6, s[16:19], s60 offen lds
    s_add_u32 m0, s59, 19456
    s_nop 0
    buffer_load_dwordx4 v7, s[16:19], s60 offen lds
    s_add_u32 s60, s62, 262144
    s_and_b32 s60, s60, 0x3fffff
    s_add_u32 m0, s59, 20480
    s_nop 0
    buffer_load_dwordx4 v4, s[16:19], s60 offen lds
    s_add_u32 m0, s59, 21504
    s_nop 0
    buffer_load_dwordx4 v5, s[16:19], s60 offen lds
    s_add_u32 m0, s59, 22528
    s_nop 0
    buffer_load_dwordx4 v6, s[16:19], s60 offen lds
    s_add_u32 m0, s59, 23552
    s_nop 0
    buffer_load_dwordx4 v7, s[16:19], s60 offen lds
    s_lshl_b32 s3, s56, 19
    s_add_u32 s20, s44, s3
    s_addc_u32 s21, s45, 0
    s_mov_b32 s22, 524288
    s_mov_b32 s23, 0x20000
    s_mov_b32 s24, s52
    s_mov_b32 s25, s53
    s_mov_b32 s26, 268435456
    s_mov_b32 s27, 0x20000
    s_mov_b32 s28, s48
    s_mov_b32 s29, s49
    s_mov_b32 s30, 2621440
    s_mov_b32 s31, 0x20000
    s_mov_b32 s32, s50
    s_mov_b32 s33, s51
    s_mov_b32 s34, 256
    s_mov_b32 s35, 0x20000
    v_bfe_u32 v244, v1, 1, 1
    v_bfe_u32 v245, v1, 3, 2
    v_lshl_or_b32 v244, v245, 1, v244
    v_lshlrev_b32 v244, 4, v244
    v_bfe_u32 v245, v1, 2, 2
    v_lshl_add_u32 v244, v245, 7, v244
    v_lshl_add_u32 v244, v2, 10, v244
    v_and_b32 v245, 1, v1
    v_lshl_add_u32 v244, v245, 3, v244
    v_add_u32 v8, s59, v244
    v_xor_b32 v9, 32, v8
    v_xor_b32 v10, 64, v8
    v_xor_b32 v11, 96, v8
    v_and_b32 v244, 6, v3
    v_xor_b32 v244, v244, v2
    v_and_b32 v245, 7, v3
    v_lshl_add_u32 v244, v245, 3, v244
    v_lshlrev_b32 v244, 4, v244
    v_lshrrev_b32 v245, 3, v3
    v_lshl_add_u32 v16, v245, 10, v244
    s_lshr_b32 s3, s55, 3
    s_lshl_b32 s3, s3, 6
    v_xor_b32 v16, s3, v16
    v_xor_b32 v17, 64, v16
    s_waitcnt vmcnt(8)
    s_barrier
    ds_read_b128 a[0:3], v16 offset:0
    ds_read_b128 a[4:7], v16 offset:2048
    ds_read_b128 a[8:11], v16 offset:4096
    ds_read_b128 a[12:15], v16 offset:6144
    ds_read_b128 a[16:19], v16 offset:8192
    ds_read_b64_tr_b16 v[32:33], v8 offset:12288
    ds_read_b64_tr_b16 v[34:35], v8 offset:12800
    ds_read_b64_tr_b16 v[36:37], v9 offset:12288
    ds_read_b64_tr_b16 v[38:39], v9 offset:12800
    s_waitcnt lgkmcnt(2)
    v_mfma_f32_16x16x32_bf16 v[48:51], v[32:35], a[0:3], 0
    ds_read_b64_tr_b16 v[40:41], v10 offset:12288
    v_xor_b32 v244, v2, v3
    v_mfma_f32_16x16x32_bf16 v[56:59], v[32:35], a[4:7], 0
    s_add_u32 s60, s60, 128
    ds_read_b64_tr_b16 v[42:43], v10 offset:12800
    s_add_u32 m0, s59, 24576
    v_mfma_f32_16x16x32_bf16 v[64:67], v[32:35], a[8:11], 0
    buffer_load_dwordx4 v4, s[16:19], s60 offen lds
    s_add_u32 m0, s59, 25600
    v_lshlrev_b32 v244, 4, v244
    v_mfma_f32_16x16x32_bf16 v[72:75], v[32:35], a[12:15], 0
    buffer_load_dwordx4 v5, s[16:19], s60 offen lds
    s_add_u32 m0, s59, 26624
    v_lshl_add_u32 v228, v2, 8, v244
    v_mfma_f32_16x16x32_bf16 v[80:83], v[32:35], a[16:19], 0
    s_waitcnt lgkmcnt(2)
    buffer_load_dwordx4 v6, s[16:19], s60 offen lds
    v_xor_b32 v229, 64, v228
    v_mfma_f32_16x16x32_bf16 v[52:55], v[36:39], a[0:3], 0
    ds_read_b64_tr_b16 v[44:45], v11 offset:12288
    v_xor_b32 v230, 128, v228
    v_mfma_f32_16x16x32_bf16 v[60:63], v[36:39], a[4:7], 0
    s_mov_b32 s67, 4096
    ds_read_b64_tr_b16 v[46:47], v11 offset:12800
    v_xor_b32 v231, 192, v228
    v_mfma_f32_16x16x32_bf16 v[68:71], v[36:39], a[8:11], 0
    s_add_u32 m0, s59, 27648
    ds_read_b128 a[20:23], v17 offset:0
    s_mov_b32 s68, 8192
    v_mfma_f32_16x16x32_bf16 v[76:79], v[36:39], a[12:15], 0
    s_mov_b32 s69, 12288
    buffer_load_dwordx4 v7, s[16:19], s60 offen lds
    s_mov_b32 s70, 16384
    v_mfma_f32_16x16x32_bf16 v[84:87], v[36:39], a[16:19], 0
    s_waitcnt vmcnt(8)
    s_waitcnt lgkmcnt(3)
    v_lshrrev_b32 v244, 1, v2
    v_mfma_f32_16x16x32_bf16 v[88:91], v[40:43], a[0:3], 0
    ds_read_b64_tr_b16 v[32:33], v8 offset:16384
    v_xor_b32 v244, v244, v3
    v_mfma_f32_16x16x32_bf16 v[96:99], v[40:43], a[4:7], 0
    ds_read_b64_tr_b16 v[34:35], v8 offset:16896
    v_lshlrev_b32 v244, 4, v244
    v_mfma_f32_16x16x32_bf16 v[104:107], v[40:43], a[8:11], 0
    ds_read_b128 a[24:27], v17 offset:2048
    v_lshl_add_u32 v244, v3, 8, v244
    v_mfma_f32_16x16x32_bf16 v[112:115], v[40:43], a[12:15], 0
    v_and_b32 v245, 1, v2
    v_lshl_add_u32 v244, v245, 3, v244
    v_mfma_f32_16x16x32_bf16 v[120:123], v[40:43], a[16:19], 0
    s_waitcnt lgkmcnt(4)
    v_add_u32 v208, s59, v244
    v_xor_b32 v209, 32, v208
    v_mfma_f32_16x16x32_bf16 v[92:95], v[44:47], a[0:3], 0
    ds_read_b64_tr_b16 v[36:37], v9 offset:16384
    v_xor_b32 v210, 64, v208
    v_mfma_f32_16x16x32_bf16 v[100:103], v[44:47], a[4:7], 0
    ds_read_b64_tr_b16 v[38:39], v9 offset:16896
    v_xor_b32 v211, 96, v208
    v_mfma_f32_16x16x32_bf16 v[108:111], v[44:47], a[8:11], 0
    s_add_u32 s60, s61, 524288
    ds_read_b128 a[28:31], v17 offset:4096
    s_and_b32 s60, s60, 0x3fffff
    s_add_u32 m0, s59, 28672
    v_mfma_f32_16x16x32_bf16 v[116:119], v[44:47], a[12:15], 0
    buffer_load_dwordx4 v4, s[16:19], s60 offen lds
    s_add_u32 m0, s59, 29696
    v_xor_b32 v212, 128, v208
    v_mfma_f32_16x16x32_bf16 v[124:127], v[44:47], a[16:19], 0
    s_waitcnt lgkmcnt(4)
    buffer_load_dwordx4 v5, s[16:19], s60 offen lds
    v_xor_b32 v213, 160, v208
    v_mfma_f32_16x16x32_bf16 v[128:131], v[32:35], a[0:3], 0
    ds_read_b64_tr_b16 v[40:41], v10 offset:16384
    v_xor_b32 v214, 192, v208
    v_mfma_f32_16x16x32_bf16 v[136:139], v[32:35], a[4:7], 0
    s_add_u32 m0, s59, 30720
    ds_read_b64_tr_b16 v[42:43], v10 offset:16896
    v_xor_b32 v215, 224, v208
    v_mfma_f32_16x16x32_bf16 v[144:147], v[32:35], a[8:11], 0
    buffer_load_dwordx4 v6, s[16:19], s60 offen lds
    s_add_u32 m0, s59, 31744
    v_lshlrev_b32 v244, 1, v2
    v_mfma_f32_16x16x32_bf16 v[152:155], v[32:35], a[12:15], 0
    buffer_load_dwordx4 v7, s[16:19], s60 offen lds
    v_xor_b32 v244, v244, v3
    v_mfma_f32_16x16x32_bf16 v[160:163], v[32:35], a[16:19], 0
    s_waitcnt lgkmcnt(3)
    v_lshlrev_b32 v244, 4, v244
    v_lshl_add_u32 v20, v2, 8, v244
    v_mfma_f32_16x16x32_bf16 v[132:135], v[36:39], a[0:3], 0
    ds_read_b64_tr_b16 v[44:45], v11 offset:16384
    v_xor_b32 v21, 128, v20
    v_mfma_f32_16x16x32_bf16 v[140:143], v[36:39], a[4:7], 0
    ds_read_b64_tr_b16 v[46:47], v11 offset:16896
    v_bfe_u32 v244, v1, 1, 4
    v_mfma_f32_16x16x32_bf16 v[148:151], v[36:39], a[8:11], 0
    ds_read_b128 a[32:35], v17 offset:6144
    v_lshlrev_b32 v244, 4, v244
    v_mfma_f32_16x16x32_bf16 v[156:159], v[36:39], a[12:15], 0
    v_lshrrev_b32 v245, 2, v1
    v_lshl_add_u32 v244, v245, 8, v244
    v_mfma_f32_16x16x32_bf16 v[164:167], v[36:39], a[16:19], 0
    s_waitcnt vmcnt(8)
    s_waitcnt lgkmcnt(3)
    v_and_b32 v245, 1, v1
    v_mfma_f32_16x16x32_bf16 v[168:171], v[40:43], a[0:3], 0
    ds_read_b64_tr_b16 v[32:33], v8 offset:20480
    v_lshl_add_u32 v244, v245, 3, v244
    v_mfma_f32_16x16x32_bf16 v[176:179], v[40:43], a[4:7], 0
    ds_read_b64_tr_b16 v[34:35], v8 offset:20992
    v_add_u32 v22, s59, v244
    v_mfma_f32_16x16x32_bf16 v[184:187], v[40:43], a[8:11], 0
    s_add_u32 s60, s60, 128
    ds_read_b128 a[36:39], v17 offset:8192
    s_add_u32 m0, s59, 32768
    v_mfma_f32_16x16x32_bf16 v[192:195], v[40:43], a[12:15], 0
    buffer_load_dwordx4 v4, s[16:19], s60 offen lds
    s_add_u32 m0, s59, 33792
    v_xor_b32 v23, 32, v22
    v_mfma_f32_16x16x32_bf16 v[200:203], v[40:43], a[16:19], 0
    s_waitcnt lgkmcnt(4)
    buffer_load_dwordx4 v5, s[16:19], s60 offen lds
    v_xor_b32 v24, 64, v22
    v_mfma_f32_16x16x32_bf16 v[172:175], v[44:47], a[0:3], 0
    ds_read_b64_tr_b16 v[36:37], v9 offset:20480
    v_xor_b32 v19, 96, v22
    v_mfma_f32_16x16x32_bf16 v[180:183], v[44:47], a[4:7], 0
    s_add_u32 m0, s59, 34816
    ds_read_b64_tr_b16 v[38:39], v9 offset:20992
    v_lshlrev_b32 v29, 4, v1
    v_mfma_f32_16x16x32_bf16 v[188:191], v[44:47], a[8:11], 0
    buffer_load_dwordx4 v6, s[16:19], s60 offen lds
    s_add_u32 m0, s59, 35840
    v_lshlrev_b32 v30, 3, v1
    v_mfma_f32_16x16x32_bf16 v[196:199], v[44:47], a[12:15], 0
    s_xor_b32 s100, s54, 1
    buffer_load_dwordx4 v7, s[16:19], s60 offen lds
    v_add_u32 v25, s59, v29
    v_mfma_f32_16x16x32_bf16 v[204:207], v[44:47], a[16:19], 0
    s_waitcnt lgkmcnt(3)
    s_waitcnt lgkmcnt(2)
    s_mul_i32 s100, s100, 40960
    v_mfma_f32_16x16x32_bf16 v[48:51], v[32:35], a[20:23], v[48:51]
    ds_read_b64_tr_b16 v[40:41], v10 offset:20480
    v_add_u32 v26, s100, v29
    s_xor_b32 s100, s54, 2
    v_mfma_f32_16x16x32_bf16 v[56:59], v[32:35], a[24:27], v[56:59]
    s_add_u32 s64, s63, 2
    ds_read_b64_tr_b16 v[42:43], v10 offset:20992
    s_and_b32 s64, s64, 7
    s_lshl_b32 s64, s64, 7
    s_add_u32 m0, s76, 81920
    s_add_u32 s65, s64, 0
    v_mfma_f32_16x16x32_bf16 v[64:67], v[32:35], a[28:31], v[64:67]
    s_mul_i32 s100, s100, 40960
    buffer_load_dwordx4 v18, s[4:7], s65 offen lds
    v_add_u32 v27, s100, v29
    v_mfma_f32_16x16x32_bf16 v[72:75], v[32:35], a[32:35], v[72:75]
    s_add_u32 m0, s76, 83968
    s_add_u32 s65, s64, 16384
    s_xor_b32 s100, s54, 3
    v_mfma_f32_16x16x32_bf16 v[80:83], v[32:35], a[36:39], v[80:83]
    s_waitcnt lgkmcnt(2)
    buffer_load_dwordx4 v18, s[4:7], s65 offen lds
    s_mul_i32 s100, s100, 40960
    v_mfma_f32_16x16x32_bf16 v[52:55], v[36:39], a[20:23], v[52:55]
    s_mov_b32 s66, 0x3e0293ee
    ds_read_b64_tr_b16 v[44:45], v11 offset:20480
    v_add_u32 v28, s100, v29
    v_mfma_f32_16x16x32_bf16 v[60:63], v[36:39], a[24:27], v[60:63]
    ds_read_b64_tr_b16 v[46:47], v11 offset:20992
    v_bfe_u32 v244, v1, 1, 1
    v_mfma_f32_16x16x32_bf16 v[68:71], v[36:39], a[28:31], v[68:71]
    s_add_u32 m0, s76, 86016
    ds_read_b128 a[0:3], v16 offset:40960
    s_add_u32 s65, s64, 32768
    v_mfma_f32_16x16x32_bf16 v[76:79], v[36:39], a[32:35], v[76:79]
    buffer_load_dwordx4 v18, s[4:7], s65 offen lds
    s_add_u32 m0, s76, 88064
    s_add_u32 s65, s64, 49152
    v_mfma_f32_16x16x32_bf16 v[84:87], v[36:39], a[36:39], v[84:87]
    s_waitcnt vmcnt(11)
    buffer_load_dwordx4 v18, s[4:7], s65 offen lds
    s_waitcnt lgkmcnt(3)
    v_mfma_f32_16x16x32_bf16 v[88:91], v[40:43], a[20:23], v[88:91]
    ds_read_b64_tr_b16 v[32:33], v8 offset:24576
    v_bfe_u32 v245, v1, 2, 3
    v_mfma_f32_16x16x32_bf16 v[96:99], v[40:43], a[24:27], v[96:99]
    ds_read_b64_tr_b16 v[34:35], v8 offset:25088
    v_and_b32 v31, 6, v245
    v_mfma_f32_16x16x32_bf16 v[104:107], v[40:43], a[28:31], v[104:107]
    s_add_u32 m0, s76, 90112
    ds_read_b128 a[4:7], v16 offset:43008
    s_add_u32 s65, s64, 65536
    v_mfma_f32_16x16x32_bf16 v[112:115], v[40:43], a[32:35], v[112:115]
    s_add_u32 s60, s62, 786432
    buffer_load_dwordx4 v18, s[4:7], s65 offen lds
    s_and_b32 s60, s60, 0x3fffff
    s_add_u32 m0, s59, 36864
    v_mfma_f32_16x16x32_bf16 v[120:123], v[40:43], a[36:39], v[120:123]
    s_waitcnt lgkmcnt(4)
    buffer_load_dwordx4 v4, s[16:19], s60 offen lds
    v_xor_b32 v244, v244, v31
    v_mfma_f32_16x16x32_bf16 v[92:95], v[44:47], a[20:23], v[92:95]
    ds_read_b64_tr_b16 v[36:37], v9 offset:24576
    v_lshlrev_b32 v244, 4, v244
    v_mfma_f32_16x16x32_bf16 v[100:103], v[44:47], a[24:27], v[100:103]
    ds_read_b64_tr_b16 v[38:39], v9 offset:25088
    v_lshl_add_u32 v244, v245, 7, v244
    v_mfma_f32_16x16x32_bf16 v[108:111], v[44:47], a[28:31], v[108:111]
    s_add_u32 m0, s59, 37888
    ds_read_b128 a[8:11], v16 offset:45056
    v_lshrrev_b32 v245, 5, v1
    v_mfma_f32_16x16x32_bf16 v[116:119], v[44:47], a[32:35], v[116:119]
    buffer_load_dwordx4 v5, s[16:19], s60 offen lds
    s_add_u32 m0, s59, 38912
    v_lshl_add_u32 v244, v245, 10, v244
    v_mfma_f32_16x16x32_bf16 v[124:127], v[44:47], a[36:39], v[124:127]
    s_waitcnt lgkmcnt(4)
    buffer_load_dwordx4 v6, s[16:19], s60 offen lds
    v_and_b32 v245, 1, v1
    v_mfma_f32_16x16x32_bf16 v[128:131], v[32:35], a[20:23], v[128:131]
    ds_read_b64_tr_b16 v[40:41], v10 offset:24576
    v_lshl_add_u32 v31, v245, 3, v244
    v_mfma_f32_16x16x32_bf16 v[136:139], v[32:35], a[24:27], v[136:139]
    s_add_u32 m0, s59, 39936
    ds_read_b64_tr_b16 v[42:43], v10 offset:25088
    v_mov_b32 v232, 0x3f803f80
    v_mfma_f32_16x16x32_bf16 v[144:147], v[32:35], a[28:31], v[144:147]
    buffer_load_dwordx4 v7, s[16:19], s60 offen lds
    s_add_u32 s60, s60, 128
    s_add_u32 m0, s59, 12288
    v_mfma_f32_16x16x32_bf16 v[152:155], v[32:35], a[32:35], v[152:155]
    buffer_load_dwordx4 v4, s[16:19], s60 offen lds
    s_add_u32 m0, s59, 13312
    v_mov_b32 v233, 0x3f803f80
    v_mfma_f32_16x16x32_bf16 v[160:163], v[32:35], a[36:39], v[160:163]
    s_waitcnt lgkmcnt(3)
    buffer_load_dwordx4 v5, s[16:19], s60 offen lds
    v_mov_b32 v234, 0x3f803f80
    v_mfma_f32_16x16x32_bf16 v[132:135], v[36:39], a[20:23], v[132:135]
    ds_read_b64_tr_b16 v[44:45], v11 offset:24576
    v_mov_b32 v235, 0x3f803f80
    v_mfma_f32_16x16x32_bf16 v[140:143], v[36:39], a[24:27], v[140:143]
    ds_read_b64_tr_b16 v[46:47], v11 offset:25088
    v_lshlrev_b32 v244, 2, v2
    v_mfma_f32_16x16x32_bf16 v[148:151], v[36:39], a[28:31], v[148:151]
    s_add_u32 m0, s59, 14336
    ds_read_b128 a[12:15], v16 offset:47104
    v_sub_u32 v244, v3, v244
    v_mfma_f32_16x16x32_bf16 v[156:159], v[36:39], a[32:35], v[156:159]
    buffer_load_dwordx4 v6, s[16:19], s60 offen lds
    s_add_u32 m0, s59, 15360
    v_mov_b32 v245, 0x3f80
    v_mfma_f32_16x16x32_bf16 v[164:167], v[36:39], a[36:39], v[164:167]
    s_waitcnt vmcnt(16)
    buffer_load_dwordx4 v7, s[16:19], s60 offen lds
    s_waitcnt lgkmcnt(3)
    v_mfma_f32_16x16x32_bf16 v[168:171], v[40:43], a[20:23], v[168:171]
    ds_read_b64_tr_b16 v[32:33], v8 offset:28672
    v_cmp_eq_u32 vcc, 0, v244
    v_mfma_f32_16x16x32_bf16 v[176:179], v[40:43], a[24:27], v[176:179]
    ds_read_b64_tr_b16 v[34:35], v8 offset:29184
    v_mov_b32 v243, 0x3f800000
    v_mfma_f32_16x16x32_bf16 v[184:187], v[40:43], a[28:31], v[184:187]
    s_add_u32 s60, s61, 1048576
    ds_read_b128 a[16:19], v16 offset:49152
    s_and_b32 s60, s60, 0x3fffff
    s_add_u32 m0, s59, 16384
    v_mfma_f32_16x16x32_bf16 v[192:195], v[40:43], a[32:35], v[192:195]
    buffer_load_dwordx4 v4, s[16:19], s60 offen lds
    s_add_u32 m0, s59, 17408
    v_cndmask_b32 v236, 0, v245, vcc
    v_mfma_f32_16x16x32_bf16 v[200:203], v[40:43], a[36:39], v[200:203]
    s_waitcnt lgkmcnt(4)
    buffer_load_dwordx4 v5, s[16:19], s60 offen lds
    v_cmp_eq_u32 vcc, 1, v244
    v_mfma_f32_16x16x32_bf16 v[172:175], v[44:47], a[20:23], v[172:175]
    ds_read_b64_tr_b16 v[36:37], v9 offset:28672
    v_cndmask_b32 v236, v236, v243, vcc
    v_mfma_f32_16x16x32_bf16 v[180:183], v[44:47], a[24:27], v[180:183]
    s_add_u32 m0, s59, 18432
    ds_read_b64_tr_b16 v[38:39], v9 offset:29184
    v_cmp_eq_u32 vcc, 2, v244
    v_mfma_f32_16x16x32_bf16 v[188:191], v[44:47], a[28:31], v[188:191]
    buffer_load_dwordx4 v6, s[16:19], s60 offen lds
    s_add_u32 m0, s59, 19456
    v_cndmask_b32 v237, 0, v245, vcc
    v_mfma_f32_16x16x32_bf16 v[196:199], v[44:47], a[32:35], v[196:199]
    buffer_load_dwordx4 v7, s[16:19], s60 offen lds
    v_cmp_eq_u32 vcc, 3, v244
    v_mfma_f32_16x16x32_bf16 v[204:207], v[44:47], a[36:39], v[204:207]
    s_waitcnt lgkmcnt(3)
    s_waitcnt lgkmcnt(2)
    v_cndmask_b32 v237, v237, v243, vcc
    v_mfma_f32_16x16x32_bf16 v[48:51], v[32:35], a[0:3], v[48:51]
    ds_read_b64_tr_b16 v[40:41], v10 offset:28672
    v_and_b32 v238, 7, v1
    v_mfma_f32_16x16x32_bf16 v[56:59], v[32:35], a[4:7], v[56:59]
    ds_read_b64_tr_b16 v[42:43], v10 offset:29184
    v_lshlrev_b32 v238, 2, v238
    v_mfma_f32_16x16x32_bf16 v[64:67], v[32:35], a[8:11], v[64:67]
    v_lshlrev_b32 v239, 11, v3
    v_lshl_add_u32 v239, v2, 3, v239
    v_mfma_f32_16x16x32_bf16 v[72:75], v[32:35], a[12:15], v[72:75]
    s_add_u32 s60, s60, 128
    s_add_u32 m0, s59, 20480
    v_lshlrev_b32 v248, 5, v1
    v_mfma_f32_16x16x32_bf16 v[80:83], v[32:35], a[16:19], v[80:83]
    s_waitcnt lgkmcnt(2)
    buffer_load_dwordx4 v4, s[16:19], s60 offen lds
    v_mov_b32 v249, 1
    v_mfma_f32_16x16x32_bf16 v[52:55], v[36:39], a[0:3], v[52:55]
    s_lshl_b32 s100, s58, 3
    ds_read_b64_tr_b16 v[44:45], v11 offset:28672
    v_mov_b32 v250, s100
    v_mfma_f32_16x16x32_bf16 v[60:63], v[36:39], a[4:7], v[60:63]
    ds_read_b64_tr_b16 v[46:47], v11 offset:29184
    v_lshrrev_b32 v244, 3, v1
    v_mfma_f32_16x16x32_bf16 v[68:71], v[36:39], a[8:11], v[68:71]
    s_add_u32 m0, s59, 21504
    ds_read_b128 a[20:23], v17 offset:40960
    v_and_b32 v245, 7, v1
    v_mfma_f32_16x16x32_bf16 v[76:79], v[36:39], a[12:15], v[76:79]
    buffer_load_dwordx4 v5, s[16:19], s60 offen lds
    s_add_u32 m0, s59, 22528
    v_lshlrev_b32 v244, 10, v244
    v_mfma_f32_16x16x32_bf16 v[84:87], v[36:39], a[16:19], v[84:87]
    s_waitcnt vmcnt(19)
    buffer_load_dwordx4 v6, s[16:19], s60 offen lds
    s_waitcnt lgkmcnt(3)
    v_mfma_f32_16x16x32_bf16 v[88:91], v[40:43], a[0:3], v[88:91]
    s_add_u32 s75, s100, s56
    ds_read_b64_tr_b16 v[32:33], v8 offset:32768
    v_lshl_add_u32 v254, v245, 7, v244
    v_mfma_f32_16x16x32_bf16 v[96:99], v[40:43], a[4:7], v[96:99]
    s_lshl_b32 s75, s75, 7
    ds_read_b64_tr_b16 v[34:35], v8 offset:33280
    s_add_u32 s75, s75, 33554432
    v_mfma_f32_16x16x32_bf16 v[104:107], v[40:43], a[8:11], v[104:107]
    s_add_u32 m0, s59, 23552
    ds_read_b128 a[24:27], v17 offset:43008
    v_mov_b32 v246, 0x80000000
    v_mfma_f32_16x16x32_bf16 v[112:115], v[40:43], a[12:15], v[112:115]
    buffer_load_dwordx4 v7, s[16:19], s60 offen lds
    v_lshlrev_b32 v244, 2, v0
    v_mfma_f32_16x16x32_bf16 v[120:123], v[40:43], a[16:19], v[120:123]
    s_waitcnt lgkmcnt(4)
    v_cmp_gt_u32 vcc, 32, v0
    v_mov_b32 v247, 1
    v_mfma_f32_16x16x32_bf16 v[92:95], v[44:47], a[0:3], v[92:95]
    ds_read_b64_tr_b16 v[36:37], v9 offset:32768
    v_mov_b32 v245, 0
    v_mfma_f32_16x16x32_bf16 v[100:103], v[44:47], a[4:7], v[100:103]
    ds_read_b64_tr_b16 v[38:39], v9 offset:33280
    v_cndmask_b32 v251, v246, v244, vcc
    v_mfma_f32_16x16x32_bf16 v[108:111], v[44:47], a[8:11], v[108:111]
    s_add_u32 s60, s62, 1310720
    ds_read_b128 a[28:31], v17 offset:45056
    s_and_b32 s60, s60, 0x3fffff
    s_add_u32 m0, s59, 24576
    v_mfma_f32_16x16x32_bf16 v[116:119], v[44:47], a[12:15], v[116:119]
    buffer_load_dwordx4 v4, s[16:19], s60 offen lds
    s_add_u32 m0, s59, 25600
    v_cmp_eq_u32 vcc, 0, v0
    v_mfma_f32_16x16x32_bf16 v[124:127], v[44:47], a[16:19], v[124:127]
    s_waitcnt lgkmcnt(4)
    buffer_load_dwordx4 v5, s[16:19], s60 offen lds
    v_mov_b32 v244, 0
    v_mfma_f32_16x16x32_bf16 v[128:131], v[32:35], a[0:3], v[128:131]
    ds_read_b64_tr_b16 v[40:41], v10 offset:32768
    s_nop 0
    v_cndmask_b32 v246, v246, v250, vcc
    v_mfma_f32_16x16x32_bf16 v[136:139], v[32:35], a[4:7], v[136:139]
    s_add_u32 m0, s59, 26624
    ds_read_b64_tr_b16 v[42:43], v10 offset:33280
    v_mfma_f32_16x16x32_bf16 v[144:147], v[32:35], a[8:11], v[144:147]
    buffer_load_dwordx4 v6, s[16:19], s60 offen lds
    s_add_u32 m0, s59, 27648
    v_mfma_f32_16x16x32_bf16 v[152:155], v[32:35], a[12:15], v[152:155]
    buffer_load_dwordx4 v7, s[16:19], s60 offen lds
    v_mfma_f32_16x16x32_bf16 v[160:163], v[32:35], a[16:19], v[160:163]
    s_waitcnt lgkmcnt(3)
    v_mfma_f32_16x16x32_bf16 v[132:135], v[36:39], a[0:3], v[132:135]
    ds_read_b64_tr_b16 v[44:45], v11 offset:32768
    v_mfma_f32_16x16x32_bf16 v[140:143], v[36:39], a[4:7], v[140:143]
    ds_read_b64_tr_b16 v[46:47], v11 offset:33280
    v_mfma_f32_16x16x32_bf16 v[148:151], v[36:39], a[8:11], v[148:151]
    ds_read_b128 a[32:35], v17 offset:47104
    v_mfma_f32_16x16x32_bf16 v[156:159], v[36:39], a[12:15], v[156:159]
    v_mfma_f32_16x16x32_bf16 v[164:167], v[36:39], a[16:19], v[164:167]
    s_waitcnt vmcnt(16)
    s_waitcnt lgkmcnt(3)
    v_mfma_f32_16x16x32_bf16 v[168:171], v[40:43], a[0:3], v[168:171]
    ds_read_b64_tr_b16 v[32:33], v8 offset:36864
    v_mfma_f32_16x16x32_bf16 v[176:179], v[40:43], a[4:7], v[176:179]
    ds_read_b64_tr_b16 v[34:35], v8 offset:37376
    v_mfma_f32_16x16x32_bf16 v[184:187], v[40:43], a[8:11], v[184:187]
    s_add_u32 s60, s60, 128
    ds_read_b128 a[36:39], v17 offset:49152
    s_add_u32 m0, s59, 28672
    v_mfma_f32_16x16x32_bf16 v[192:195], v[40:43], a[12:15], v[192:195]
    buffer_load_dwordx4 v4, s[16:19], s60 offen lds
    s_add_u32 m0, s59, 29696
    v_mfma_f32_16x16x32_bf16 v[200:203], v[40:43], a[16:19], v[200:203]
    s_waitcnt lgkmcnt(4)
    buffer_load_dwordx4 v5, s[16:19], s60 offen lds
    v_mfma_f32_16x16x32_bf16 v[172:175], v[44:47], a[0:3], v[172:175]
    ds_read_b64_tr_b16 v[36:37], v9 offset:36864
    v_mfma_f32_16x16x32_bf16 v[180:183], v[44:47], a[4:7], v[180:183]
    s_add_u32 m0, s59, 30720
    ds_read_b64_tr_b16 v[38:39], v9 offset:37376
    v_mfma_f32_16x16x32_bf16 v[188:191], v[44:47], a[8:11], v[188:191]
    buffer_load_dwordx4 v6, s[16:19], s60 offen lds
    s_add_u32 m0, s59, 31744
    v_mfma_f32_16x16x32_bf16 v[196:199], v[44:47], a[12:15], v[196:199]
    buffer_load_dwordx4 v7, s[16:19], s60 offen lds
    v_mfma_f32_16x16x32_bf16 v[204:207], v[44:47], a[16:19], v[204:207]
    s_waitcnt lgkmcnt(3)
    s_waitcnt lgkmcnt(2)
    s_barrier
    v_xor_b32 v16, 0x14000, v16
    v_mfma_f32_16x16x32_bf16 v[48:51], v[32:35], a[20:23], v[48:51]
    ds_read_b64_tr_b16 v[40:41], v10 offset:36864
    v_mfma_f32_16x16x32_bf16 v[56:59], v[32:35], a[24:27], v[56:59]
    ds_read_b64_tr_b16 v[42:43], v10 offset:37376
    v_mfma_f32_16x16x32_bf16 v[64:67], v[32:35], a[28:31], v[64:67]
    s_add_u32 s60, s61, 1572864
    s_and_b32 s60, s60, 0x3fffff
    s_add_u32 m0, s59, 32768
    v_mfma_f32_16x16x32_bf16 v[72:75], v[32:35], a[32:35], v[72:75]
    buffer_load_dwordx4 v4, s[16:19], s60 offen lds
    s_add_u32 m0, s59, 33792
    v_mfma_f32_16x16x32_bf16 v[80:83], v[32:35], a[36:39], v[80:83]
    s_waitcnt lgkmcnt(2)
    buffer_load_dwordx4 v5, s[16:19], s60 offen lds
    v_mfma_f32_16x16x32_bf16 v[52:55], v[36:39], a[20:23], v[52:55]
    ds_read_b64_tr_b16 v[44:45], v11 offset:36864
    v_mfma_f32_16x16x32_bf16 v[60:63], v[36:39], a[24:27], v[60:63]
    ds_read_b64_tr_b16 v[46:47], v11 offset:37376
    v_mfma_f32_16x16x32_bf16 v[68:71], v[36:39], a[28:31], v[68:71]
    s_add_u32 m0, s59, 34816
    ds_read_b128 a[0:3], v16 offset:0
    v_mfma_f32_16x16x32_bf16 v[76:79], v[36:39], a[32:35], v[76:79]
    buffer_load_dwordx4 v6, s[16:19], s60 offen lds
    s_add_u32 m0, s59, 35840
    v_mfma_f32_16x16x32_bf16 v[84:87], v[36:39], a[36:39], v[84:87]
    s_waitcnt vmcnt(19)
    buffer_load_dwordx4 v7, s[16:19], s60 offen lds
    s_waitcnt lgkmcnt(3)
    v_mfma_f32_16x16x32_bf16 v[88:91], v[40:43], a[20:23], v[88:91]
    ds_read_b64_tr_b16 v[32:33], v8 offset:12288
    v_mfma_f32_16x16x32_bf16 v[96:99], v[40:43], a[24:27], v[96:99]
    ds_read_b64_tr_b16 v[34:35], v8 offset:12800
    v_mfma_f32_16x16x32_bf16 v[104:107], v[40:43], a[28:31], v[104:107]
    ds_read_b128 a[4:7], v16 offset:2048
    v_mfma_f32_16x16x32_bf16 v[112:115], v[40:43], a[32:35], v[112:115]
    v_mfma_f32_16x16x32_bf16 v[120:123], v[40:43], a[36:39], v[120:123]
    s_waitcnt lgkmcnt(4)
    v_mfma_f32_16x16x32_bf16 v[92:95], v[44:47], a[20:23], v[92:95]
    ds_read_b64_tr_b16 v[36:37], v9 offset:12288
    v_mfma_f32_16x16x32_bf16 v[100:103], v[44:47], a[24:27], v[100:103]
    ds_read_b64_tr_b16 v[38:39], v9 offset:12800
    v_mfma_f32_16x16x32_bf16 v[108:111], v[44:47], a[28:31], v[108:111]
    s_add_u32 s60, s60, 128
    ds_read_b128 a[8:11], v16 offset:4096
    s_add_u32 m0, s59, 36864
    v_mfma_f32_16x16x32_bf16 v[116:119], v[44:47], a[32:35], v[116:119]
    buffer_load_dwordx4 v4, s[16:19], s60 offen lds
    s_add_u32 m0, s59, 37888
    v_mfma_f32_16x16x32_bf16 v[124:127], v[44:47], a[36:39], v[124:127]
    s_waitcnt lgkmcnt(4)
    buffer_load_dwordx4 v5, s[16:19], s60 offen lds
    v_mfma_f32_16x16x32_bf16 v[128:131], v[32:35], a[20:23], v[128:131]
    ds_read_b64_tr_b16 v[40:41], v10 offset:12288
    v_mfma_f32_16x16x32_bf16 v[136:139], v[32:35], a[24:27], v[136:139]
    s_add_u32 m0, s59, 38912
    ds_read_b64_tr_b16 v[42:43], v10 offset:12800
    v_mfma_f32_16x16x32_bf16 v[144:147], v[32:35], a[28:31], v[144:147]
    buffer_load_dwordx4 v6, s[16:19], s60 offen lds
    s_add_u32 m0, s59, 39936
    v_mfma_f32_16x16x32_bf16 v[152:155], v[32:35], a[32:35], v[152:155]
    buffer_load_dwordx4 v7, s[16:19], s60 offen lds
    v_mfma_f32_16x16x32_bf16 v[160:163], v[32:35], a[36:39], v[160:163]
    s_waitcnt lgkmcnt(3)
    v_mfma_f32_16x16x32_bf16 v[132:135], v[36:39], a[20:23], v[132:135]
    ds_read_b64_tr_b16 v[44:45], v11 offset:12288
    v_mfma_f32_16x16x32_bf16 v[140:143], v[36:39], a[24:27], v[140:143]
    ds_read_b64_tr_b16 v[46:47], v11 offset:12800
    v_mfma_f32_16x16x32_bf16 v[148:151], v[36:39], a[28:31], v[148:151]
    ds_read_b128 a[12:15], v16 offset:6144
    v_mfma_f32_16x16x32_bf16 v[156:159], v[36:39], a[32:35], v[156:159]
    v_mfma_f32_16x16x32_bf16 v[164:167], v[36:39], a[36:39], v[164:167]
    s_waitcnt vmcnt(20)
    s_waitcnt lgkmcnt(3)
    v_mfma_f32_16x16x32_bf16 v[168:171], v[40:43], a[20:23], v[168:171]
    ds_read_b64_tr_b16 v[32:33], v8 offset:16384
    v_mfma_f32_16x16x32_bf16 v[176:179], v[40:43], a[24:27], v[176:179]
    ds_read_b64_tr_b16 v[34:35], v8 offset:16896
    v_mfma_f32_16x16x32_bf16 v[184:187], v[40:43], a[28:31], v[184:187]
    s_add_u32 s64, s63, 4
    ds_read_b128 a[16:19], v16 offset:8192
    s_and_b32 s64, s64, 7
    s_lshl_b32 s64, s64, 7
    s_add_u32 m0, s76, 0
    s_add_u32 s65, s64, 0
    v_mfma_f32_16x16x32_bf16 v[192:195], v[40:43], a[32:35], v[192:195]
    buffer_load_dwordx4 v18, s[4:7], s65 offen lds
    s_add_u32 m0, s76, 2048
    s_add_u32 s65, s64, 16384
    v_mfma_f32_16x16x32_bf16 v[200:203], v[40:43], a[36:39], v[200:203]
    s_waitcnt lgkmcnt(4)
    buffer_load_dwordx4 v18, s[4:7], s65 offen lds
    v_mfma_f32_16x16x32_bf16 v[172:175], v[44:47], a[20:23], v[172:175]
    ds_read_b64_tr_b16 v[36:37], v9 offset:16384
    v_mfma_f32_16x16x32_bf16 v[180:183], v[44:47], a[24:27], v[180:183]
    s_add_u32 m0, s76, 4096
    ds_read_b64_tr_b16 v[38:39], v9 offset:16896
    s_add_u32 s65, s64, 32768
    v_mfma_f32_16x16x32_bf16 v[188:191], v[44:47], a[28:31], v[188:191]
    buffer_load_dwordx4 v18, s[4:7], s65 offen lds
    s_add_u32 m0, s76, 6144
    s_add_u32 s65, s64, 49152
    v_mfma_f32_16x16x32_bf16 v[196:199], v[44:47], a[32:35], v[196:199]
    buffer_load_dwordx4 v18, s[4:7], s65 offen lds
    s_add_u32 m0, s76, 8192
    s_add_u32 s65, s64, 65536
    v_mfma_f32_16x16x32_bf16 v[204:207], v[44:47], a[36:39], v[204:207]
    s_waitcnt lgkmcnt(3)
    buffer_load_dwordx4 v18, s[4:7], s65 offen lds
    s_waitcnt lgkmcnt(2)
    v_xor_b32 v17, 0x14000, v17
    v_mfma_f32_16x16x32_bf16 v[48:51], v[32:35], a[0:3], v[48:51]
    ds_read_b64_tr_b16 v[40:41], v10 offset:16384
    v_mfma_f32_16x16x32_bf16 v[56:59], v[32:35], a[4:7], v[56:59]
    s_add_u32 m0, s59, 12288
    ds_read_b64_tr_b16 v[42:43], v10 offset:16896
    v_mfma_f32_16x16x32_bf16 v[64:67], v[32:35], a[8:11], v[64:67]
    buffer_load_dwordx4 v228, s[8:11], 0 offen offset:0 nt lds
    s_add_u32 m0, s59, 12288
    v_mfma_f32_16x16x32_bf16 v[72:75], v[32:35], a[12:15], v[72:75]
    buffer_load_dwordx4 v229, s[8:11], 0 offen offset:1024 nt lds
    s_add_u32 m0, s59, 12288
    v_mfma_f32_16x16x32_bf16 v[80:83], v[32:35], a[16:19], v[80:83]
    s_waitcnt lgkmcnt(2)
    buffer_load_dwordx4 v230, s[8:11], 0 offen offset:2048 nt lds
    v_mfma_f32_16x16x32_bf16 v[52:55], v[36:39], a[0:3], v[52:55]
    ds_read_b64_tr_b16 v[44:45], v11 offset:16384
    v_mfma_f32_16x16x32_bf16 v[60:63], v[36:39], a[4:7], v[60:63]
    ds_read_b64_tr_b16 v[46:47], v11 offset:16896
    v_mfma_f32_16x16x32_bf16 v[68:71], v[36:39], a[8:11], v[68:71]
    s_add_u32 m0, s59, 12288
    ds_read_b128 a[20:23], v17 offset:0
    v_mfma_f32_16x16x32_bf16 v[76:79], v[36:39], a[12:15], v[76:79]
    buffer_load_dwordx4 v231, s[8:11], 0 offen offset:3072 nt lds
    v_mfma_f32_16x16x32_bf16 v[84:87], v[36:39], a[16:19], v[84:87]
    s_waitcnt vmcnt(25)
    s_waitcnt lgkmcnt(3)
    v_mfma_f32_16x16x32_bf16 v[88:91], v[40:43], a[0:3], v[88:91]
    ds_read_b64_tr_b16 v[32:33], v8 offset:20480
    v_mfma_f32_16x16x32_bf16 v[96:99], v[40:43], a[4:7], v[96:99]
    ds_read_b64_tr_b16 v[34:35], v8 offset:20992
    v_mfma_f32_16x16x32_bf16 v[104:107], v[40:43], a[8:11], v[104:107]
    ds_read_b128 a[24:27], v17 offset:2048
    v_mfma_f32_16x16x32_bf16 v[112:115], v[40:43], a[12:15], v[112:115]
    v_mfma_f32_16x16x32_bf16 v[120:123], v[40:43], a[16:19], v[120:123]
    s_waitcnt lgkmcnt(4)
    v_mfma_f32_16x16x32_bf16 v[92:95], v[44:47], a[0:3], v[92:95]
    ds_read_b64_tr_b16 v[36:37], v9 offset:20480
    v_mfma_f32_16x16x32_bf16 v[100:103], v[44:47], a[4:7], v[100:103]
    ds_read_b64_tr_b16 v[38:39], v9 offset:20992
    v_mfma_f32_16x16x32_bf16 v[108:111], v[44:47], a[8:11], v[108:111]
    ds_read_b128 a[28:31], v17 offset:4096
    v_mfma_f32_16x16x32_bf16 v[116:119], v[44:47], a[12:15], v[116:119]
    v_mfma_f32_16x16x32_bf16 v[124:127], v[44:47], a[16:19], v[124:127]
    s_waitcnt lgkmcnt(4)
    v_mfma_f32_16x16x32_bf16 v[128:131], v[32:35], a[0:3], v[128:131]
    ds_read_b64_tr_b16 v[40:41], v10 offset:20480
    v_mfma_f32_16x16x32_bf16 v[136:139], v[32:35], a[4:7], v[136:139]
    s_add_u32 s60, s62, 1835008
    ds_read_b64_tr_b16 v[42:43], v10 offset:20992
    s_and_b32 s60, s60, 0x3fffff
    s_add_u32 m0, s59, 16384
    v_mfma_f32_16x16x32_bf16 v[144:147], v[32:35], a[8:11], v[144:147]
    buffer_load_dwordx4 v4, s[16:19], s60 offen lds
    s_add_u32 m0, s59, 17408
    v_mfma_f32_16x16x32_bf16 v[152:155], v[32:35], a[12:15], v[152:155]
    buffer_load_dwordx4 v5, s[16:19], s60 offen lds
    s_add_u32 m0, s59, 18432
    v_mfma_f32_16x16x32_bf16 v[160:163], v[32:35], a[16:19], v[160:163]
    s_waitcnt lgkmcnt(3)
    buffer_load_dwordx4 v6, s[16:19], s60 offen lds
    v_mfma_f32_16x16x32_bf16 v[132:135], v[36:39], a[0:3], v[132:135]
    ds_read_b64_tr_b16 v[44:45], v11 offset:20480
    v_mfma_f32_16x16x32_bf16 v[140:143], v[36:39], a[4:7], v[140:143]
    ds_read_b64_tr_b16 v[46:47], v11 offset:20992
    v_mfma_f32_16x16x32_bf16 v[148:151], v[36:39], a[8:11], v[148:151]
    s_add_u32 m0, s59, 19456
    ds_read_b128 a[32:35], v17 offset:6144
    v_mfma_f32_16x16x32_bf16 v[156:159], v[36:39], a[12:15], v[156:159]
    buffer_load_dwordx4 v7, s[16:19], s60 offen lds
    v_mfma_f32_16x16x32_bf16 v[164:167], v[36:39], a[16:19], v[164:167]
    s_waitcnt vmcnt(25)
    s_waitcnt lgkmcnt(3)
    v_mfma_f32_16x16x32_bf16 v[168:171], v[40:43], a[0:3], v[168:171]
    ds_read_b64_tr_b16 v[32:33], v8 offset:24576
    v_mfma_f32_16x16x32_bf16 v[176:179], v[40:43], a[4:7], v[176:179]
    ds_read_b64_tr_b16 v[34:35], v8 offset:25088
    v_mfma_f32_16x16x32_bf16 v[184:187], v[40:43], a[8:11], v[184:187]
    ds_read_b128 a[36:39], v17 offset:8192
    v_mfma_f32_16x16x32_bf16 v[192:195], v[40:43], a[12:15], v[192:195]
    v_mfma_f32_16x16x32_bf16 v[200:203], v[40:43], a[16:19], v[200:203]
    s_waitcnt lgkmcnt(4)
    v_mfma_f32_16x16x32_bf16 v[172:175], v[44:47], a[0:3], v[172:175]
    ds_read_b64_tr_b16 v[36:37], v9 offset:24576
    v_mfma_f32_16x16x32_bf16 v[180:183], v[44:47], a[4:7], v[180:183]
    s_add_u32 s60, s60, 128
    ds_read_b64_tr_b16 v[38:39], v9 offset:25088
    s_add_u32 m0, s59, 20480
    v_mfma_f32_16x16x32_bf16 v[188:191], v[44:47], a[8:11], v[188:191]
    buffer_load_dwordx4 v4, s[16:19], s60 offen lds
    s_add_u32 m0, s59, 21504
    v_mfma_f32_16x16x32_bf16 v[196:199], v[44:47], a[12:15], v[196:199]
    buffer_load_dwordx4 v5, s[16:19], s60 offen lds
    s_add_u32 m0, s59, 22528
    v_mfma_f32_16x16x32_bf16 v[204:207], v[44:47], a[16:19], v[204:207]
    s_waitcnt lgkmcnt(3)
    buffer_load_dwordx4 v6, s[16:19], s60 offen lds
    s_waitcnt lgkmcnt(2)
    v_mfma_f32_16x16x32_bf16 v[48:51], v[32:35], a[20:23], v[48:51]
    ds_read_b64_tr_b16 v[40:41], v10 offset:24576
    v_mfma_f32_16x16x32_bf16 v[56:59], v[32:35], a[24:27], v[56:59]
    s_add_u32 m0, s59, 23552
    ds_read_b64_tr_b16 v[42:43], v10 offset:25088
    v_mfma_f32_16x16x32_bf16 v[64:67], v[32:35], a[28:31], v[64:67]
    buffer_load_dwordx4 v7, s[16:19], s60 offen lds
    v_mfma_f32_16x16x32_bf16 v[72:75], v[32:35], a[32:35], v[72:75]
    v_mfma_f32_16x16x32_bf16 v[80:83], v[32:35], a[36:39], v[80:83]
    s_waitcnt lgkmcnt(2)
    v_mfma_f32_16x16x32_bf16 v[52:55], v[36:39], a[20:23], v[52:55]
    ds_read_b64_tr_b16 v[44:45], v11 offset:24576
    v_mfma_f32_16x16x32_bf16 v[60:63], v[36:39], a[24:27], v[60:63]
    ds_read_b64_tr_b16 v[46:47], v11 offset:25088
    v_mfma_f32_16x16x32_bf16 v[68:71], v[36:39], a[28:31], v[68:71]
    ds_read_b128 a[0:3], v16 offset:40960
    v_mfma_f32_16x16x32_bf16 v[76:79], v[36:39], a[32:35], v[76:79]
    v_mfma_f32_16x16x32_bf16 v[84:87], v[36:39], a[36:39], v[84:87]
    s_waitcnt vmcnt(25)
    s_waitcnt lgkmcnt(3)
    v_mfma_f32_16x16x32_bf16 v[88:91], v[40:43], a[20:23], v[88:91]
    ds_read_b64_tr_b16 v[32:33], v8 offset:28672
    v_mfma_f32_16x16x32_bf16 v[96:99], v[40:43], a[24:27], v[96:99]
    ds_read_b64_tr_b16 v[34:35], v8 offset:29184
    v_mfma_f32_16x16x32_bf16 v[104:107], v[40:43], a[28:31], v[104:107]
    ds_read_b128 a[4:7], v16 offset:43008
    v_mfma_f32_16x16x32_bf16 v[112:115], v[40:43], a[32:35], v[112:115]
    v_mfma_f32_16x16x32_bf16 v[120:123], v[40:43], a[36:39], v[120:123]
    s_waitcnt lgkmcnt(4)
    v_mfma_f32_16x16x32_bf16 v[92:95], v[44:47], a[20:23], v[92:95]
    ds_read_b64_tr_b16 v[36:37], v9 offset:28672
    v_mfma_f32_16x16x32_bf16 v[100:103], v[44:47], a[24:27], v[100:103]
    ds_read_b64_tr_b16 v[38:39], v9 offset:29184
    v_mfma_f32_16x16x32_bf16 v[108:111], v[44:47], a[28:31], v[108:111]
    s_add_u32 m0, s59, 24576
    ds_read_b128 a[8:11], v16 offset:45056
    v_mfma_f32_16x16x32_bf16 v[116:119], v[44:47], a[32:35], v[116:119]
    buffer_load_dwordx4 v228, s[8:11], s67 offen offset:0 nt lds
    s_add_u32 m0, s59, 24576
    v_mfma_f32_16x16x32_bf16 v[124:127], v[44:47], a[36:39], v[124:127]
    s_waitcnt lgkmcnt(4)
    buffer_load_dwordx4 v229, s[8:11], s67 offen offset:1024 nt lds
    v_mfma_f32_16x16x32_bf16 v[128:131], v[32:35], a[20:23], v[128:131]
    ds_read_b64_tr_b16 v[40:41], v10 offset:28672
    v_mfma_f32_16x16x32_bf16 v[136:139], v[32:35], a[24:27], v[136:139]
    s_add_u32 m0, s59, 24576
    ds_read_b64_tr_b16 v[42:43], v10 offset:29184
    v_mfma_f32_16x16x32_bf16 v[144:147], v[32:35], a[28:31], v[144:147]
    buffer_load_dwordx4 v230, s[8:11], s67 offen offset:2048 nt lds
    s_add_u32 m0, s59, 24576
    v_mfma_f32_16x16x32_bf16 v[152:155], v[32:35], a[32:35], v[152:155]
    s_waitcnt vmcnt(11)
    buffer_load_dwordx4 v231, s[8:11], s67 offen offset:3072 nt lds
    v_mfma_f32_16x16x32_bf16 v[160:163], v[32:35], a[36:39], v[160:163]
    s_waitcnt lgkmcnt(3)
    ds_read_b64 a[40:41], v208 offset:12288
    v_mfma_f32_16x16x32_bf16 v[132:135], v[36:39], a[20:23], v[132:135]
    ds_read_b64_tr_b16 v[44:45], v11 offset:28672
    v_mfma_f32_16x16x32_bf16 v[140:143], v[36:39], a[24:27], v[140:143]
    ds_read_b64_tr_b16 v[46:47], v11 offset:29184
    v_mfma_f32_16x16x32_bf16 v[148:151], v[36:39], a[28:31], v[148:151]
    ds_read_b128 a[12:15], v16 offset:47104
    v_mfma_f32_16x16x32_bf16 v[156:159], v[36:39], a[32:35], v[156:159]
    ds_read_b64 a[42:43], v209 offset:12288
    v_mfma_f32_16x16x32_bf16 v[164:167], v[36:39], a[36:39], v[164:167]
    ds_read_b64 a[44:45], v210 offset:12288
    s_waitcnt lgkmcnt(6)
    v_mfma_f32_16x16x32_bf16 v[168:171], v[40:43], a[20:23], v[168:171]
    ds_read_b64_tr_b16 v[32:33], v8 offset:32768
    v_mfma_f32_16x16x32_bf16 v[176:179], v[40:43], a[24:27], v[176:179]
    ds_read_b64_tr_b16 v[34:35], v8 offset:33280
    v_mfma_f32_16x16x32_bf16 v[184:187], v[40:43], a[28:31], v[184:187]
    ds_read_b128 a[16:19], v16 offset:49152
    v_mfma_f32_16x16x32_bf16 v[192:195], v[40:43], a[32:35], v[192:195]
    ds_read_b64 a[46:47], v211 offset:12288
    v_mfma_f32_16x16x32_bf16 v[200:203], v[40:43], a[36:39], v[200:203]
    s_waitcnt lgkmcnt(7)
    ds_read_b64 a[48:49], v212 offset:12288
    v_mfma_f32_16x16x32_bf16 v[172:175], v[44:47], a[20:23], v[172:175]
    ds_read_b64_tr_b16 v[36:37], v9 offset:32768
    v_mfma_f32_16x16x32_bf16 v[180:183], v[44:47], a[24:27], v[180:183]
    ds_read_b64 a[50:51], v213 offset:12288
    ds_read_b64_tr_b16 v[38:39], v9 offset:33280
    v_mfma_f32_16x16x32_bf16 v[188:191], v[44:47], a[28:31], v[188:191]
    s_add_u32 s60, s61, 2097152
    ds_read_b64 a[52:53], v214 offset:12288
    s_and_b32 s60, s60, 0x3fffff
    s_add_u32 m0, s59, 28672
    v_mfma_f32_16x16x32_bf16 v[196:199], v[44:47], a[32:35], v[196:199]
    ds_read_b64 a[54:55], v215 offset:12288
    buffer_load_dwordx4 v4, s[16:19], s60 offen lds
    s_add_u32 m0, s59, 29696
    v_mfma_f32_16x16x32_bf16 v[204:207], v[44:47], a[36:39], v[204:207]
    s_waitcnt lgkmcnt(8)
    buffer_load_dwordx4 v5, s[16:19], s60 offen lds
    s_waitcnt lgkmcnt(7)
    v_mfma_f32_16x16x32_bf16 v[48:51], v[32:35], a[0:3], v[48:51]
    ds_read_b64_tr_b16 v[40:41], v10 offset:32768
    v_xor_b32 v12, 0, v31
    v_mfma_f32_16x16x32_bf16 v[56:59], v[32:35], a[4:7], v[56:59]
    s_add_u32 m0, s59, 30720
    ds_read_b64_tr_b16 v[42:43], v10 offset:33280
    v_add_u32 v12, s59, v12
    v_mfma_f32_16x16x32_bf16 v[64:67], v[32:35], a[8:11], v[64:67]
    buffer_load_dwordx4 v6, s[16:19], s60 offen lds
    s_add_u32 m0, s59, 31744
    v_xor_b32 v13, 32, v31
    v_mfma_f32_16x16x32_bf16 v[72:75], v[32:35], a[12:15], v[72:75]
    buffer_load_dwordx4 v7, s[16:19], s60 offen lds
    v_add_u32 v13, s59, v13
    v_mfma_f32_16x16x32_bf16 v[80:83], v[32:35], a[16:19], v[80:83]
    s_waitcnt lgkmcnt(4)
    v_xor_b32 v14, 64, v31
    v_add_u32 v14, s59, v14
    v_mfma_f32_16x16x32_bf16 v[52:55], v[36:39], a[0:3], v[52:55]
    ds_read_b64_tr_b16 v[44:45], v11 offset:32768
    v_xor_b32 v15, 96, v31
    v_mfma_f32_16x16x32_bf16 v[60:63], v[36:39], a[4:7], v[60:63]
    ds_read_b64_tr_b16 v[46:47], v11 offset:33280
    v_add_u32 v15, s59, v15
    v_mfma_f32_16x16x32_bf16 v[68:71], v[36:39], a[8:11], v[68:71]
    ds_read_b128 a[20:23], v17 offset:40960
    v_mfma_f32_16x16x32_bf16 v[76:79], v[36:39], a[12:15], v[76:79]
    v_mfma_f32_16x16x32_bf16 v[84:87], v[36:39], a[16:19], v[84:87]
    s_waitcnt lgkmcnt(3)
    v_mfma_f32_16x16x32_bf16 v[88:91], v[40:43], a[0:3], v[88:91]
    ds_read_b64_tr_b16 v[32:33], v8 offset:36864
    v_mfma_f32_16x16x32_bf16 v[96:99], v[40:43], a[4:7], v[96:99]
    ds_read_b64_tr_b16 v[34:35], v8 offset:37376
    v_mfma_f32_16x16x32_bf16 v[104:107], v[40:43], a[8:11], v[104:107]
    ds_read_b128 a[24:27], v17 offset:43008
    v_mfma_f32_16x16x32_bf16 v[112:115], v[40:43], a[12:15], v[112:115]
    s_add_u32 s60, s60, 128
    s_add_u32 m0, s59, 12288
    v_mfma_f32_16x16x32_bf16 v[120:123], v[40:43], a[16:19], v[120:123]
    s_waitcnt lgkmcnt(4)
    buffer_load_dwordx4 v4, s[16:19], s60 offen lds
    v_mfma_f32_16x16x32_bf16 v[92:95], v[44:47], a[0:3], v[92:95]
    ds_read_b64_tr_b16 v[36:37], v9 offset:36864
    v_mfma_f32_16x16x32_bf16 v[100:103], v[44:47], a[4:7], v[100:103]
    ds_read_b64_tr_b16 v[38:39], v9 offset:37376
    v_mfma_f32_16x16x32_bf16 v[108:111], v[44:47], a[8:11], v[108:111]
    s_add_u32 m0, s59, 13312
    ds_read_b128 a[28:31], v17 offset:45056
    v_mfma_f32_16x16x32_bf16 v[116:119], v[44:47], a[12:15], v[116:119]
    buffer_load_dwordx4 v5, s[16:19], s60 offen lds
    s_add_u32 m0, s59, 14336
    v_mfma_f32_16x16x32_bf16 v[124:127], v[44:47], a[16:19], v[124:127]
    s_waitcnt lgkmcnt(4)
    buffer_load_dwordx4 v6, s[16:19], s60 offen lds
    v_mfma_f32_16x16x32_bf16 v[128:131], v[32:35], a[0:3], v[128:131]
    ds_read_b64_tr_b16 v[40:41], v10 offset:36864
    v_mfma_f32_16x16x32_bf16 v[136:139], v[32:35], a[4:7], v[136:139]
    s_add_u32 m0, s59, 15360
    ds_read_b64_tr_b16 v[42:43], v10 offset:37376
    v_mfma_f32_16x16x32_bf16 v[144:147], v[32:35], a[8:11], v[144:147]
    buffer_load_dwordx4 v7, s[16:19], s60 offen lds
    s_add_u32 m0, s59, 32768
    v_mfma_f32_16x16x32_bf16 v[152:155], v[32:35], a[12:15], v[152:155]
    buffer_load_dwordx4 v228, s[8:11], s68 offen offset:0 nt lds
    s_add_u32 m0, s59, 32768
    v_mfma_f32_16x16x32_bf16 v[160:163], v[32:35], a[16:19], v[160:163]
    s_waitcnt lgkmcnt(3)
    buffer_load_dwordx4 v229, s[8:11], s68 offen offset:1024 nt lds
    v_mfma_f32_16x16x32_bf16 v[132:135], v[36:39], a[0:3], v[132:135]
    ds_read_b64_tr_b16 v[44:45], v11 offset:36864
    v_mfma_f32_16x16x32_bf16 v[140:143], v[36:39], a[4:7], v[140:143]
    ds_read_b64_tr_b16 v[46:47], v11 offset:37376
    v_mfma_f32_16x16x32_bf16 v[148:151], v[36:39], a[8:11], v[148:151]
    s_add_u32 m0, s59, 32768
    ds_read_b128 a[32:35], v17 offset:47104
    v_mfma_f32_16x16x32_bf16 v[156:159], v[36:39], a[12:15], v[156:159]
    buffer_load_dwordx4 v230, s[8:11], s68 offen offset:2048 nt lds
    s_add_u32 m0, s59, 32768
    v_mfma_f32_16x16x32_bf16 v[164:167], v[36:39], a[16:19], v[164:167]
    s_waitcnt vmcnt(19)
    buffer_load_dwordx4 v231, s[8:11], s68 offen offset:3072 nt lds
    s_waitcnt lgkmcnt(3)
    v_mfma_f32_16x16x32_bf16 v[168:171], v[40:43], a[0:3], v[168:171]
    ds_read_b64_tr_b16 v[32:33], v8 offset:16384
    v_mfma_f32_16x16x32_bf16 v[176:179], v[40:43], a[4:7], v[176:179]
    ds_read_b64_tr_b16 v[34:35], v8 offset:16896
    v_mfma_f32_16x16x32_bf16 v[184:187], v[40:43], a[8:11], v[184:187]
    s_waitcnt vmcnt(12)
    ds_read_b128 a[36:39], v17 offset:49152
    v_mfma_f32_16x16x32_bf16 v[192:195], v[40:43], a[12:15], v[192:195]
    ds_read_b64 a[56:57], v208 offset:24576
    v_mfma_f32_16x16x32_bf16 v[200:203], v[40:43], a[16:19], v[200:203]
    s_waitcnt lgkmcnt(5)
    ds_read_b64 a[58:59], v209 offset:24576
    v_mfma_f32_16x16x32_bf16 v[172:175], v[44:47], a[0:3], v[172:175]
    ds_read_b64_tr_b16 v[36:37], v9 offset:16384
    v_mfma_f32_16x16x32_bf16 v[180:183], v[44:47], a[4:7], v[180:183]
    ds_read_b64_tr_b16 v[38:39], v9 offset:16896
    v_mfma_f32_16x16x32_bf16 v[188:191], v[44:47], a[8:11], v[188:191]
    ds_read_b64 a[60:61], v210 offset:24576
    v_mfma_f32_16x16x32_bf16 v[196:199], v[44:47], a[12:15], v[196:199]
    ds_read_b64 a[62:63], v211 offset:24576
    v_mfma_f32_16x16x32_bf16 v[204:207], v[44:47], a[16:19], v[204:207]
    s_waitcnt lgkmcnt(7)
    ds_read_b64 a[64:65], v212 offset:24576
    s_waitcnt lgkmcnt(7)
    s_barrier
    v_xor_b32 v16, 0x14000, v16
    v_mfma_f32_16x16x32_bf16 v[48:51], v[32:35], a[20:23], v[48:51]
    ds_read_b64_tr_b16 v[40:41], v10 offset:16384
    v_mfma_f32_16x16x32_bf16 v[56:59], v[32:35], a[24:27], v[56:59]
    ds_read_b64_tr_b16 v[42:43], v10 offset:16896
    v_mfma_f32_16x16x32_bf16 v[64:67], v[32:35], a[28:31], v[64:67]
    s_add_u32 s60, s62, 2359296
    ds_read_b64 a[66:67], v213 offset:24576
    s_and_b32 s60, s60, 0x3fffff
    s_add_u32 m0, s59, 36864
    v_mfma_f32_16x16x32_bf16 v[72:75], v[32:35], a[32:35], v[72:75]
    buffer_load_dwordx4 v4, s[16:19], s60 offen lds
    s_add_u32 m0, s59, 37888
    v_mfma_f32_16x16x32_bf16 v[80:83], v[32:35], a[36:39], v[80:83]
    s_waitcnt lgkmcnt(6)
    buffer_load_dwordx4 v5, s[16:19], s60 offen lds
    v_mfma_f32_16x16x32_bf16 v[52:55], v[36:39], a[20:23], v[52:55]
    ds_read_b64_tr_b16 v[44:45], v11 offset:16384
    v_mfma_f32_16x16x32_bf16 v[60:63], v[36:39], a[24:27], v[60:63]
    ds_read_b64_tr_b16 v[46:47], v11 offset:16896
    v_mfma_f32_16x16x32_bf16 v[68:71], v[36:39], a[28:31], v[68:71]
    s_add_u32 m0, s59, 38912
    ds_read_b128 a[0:3], v16 offset:0
    v_mfma_f32_16x16x32_bf16 v[76:79], v[36:39], a[32:35], v[76:79]
    buffer_load_dwordx4 v6, s[16:19], s60 offen lds
    s_add_u32 m0, s59, 39936
    v_mfma_f32_16x16x32_bf16 v[84:87], v[36:39], a[36:39], v[84:87]
    buffer_load_dwordx4 v7, s[16:19], s60 offen lds
    s_waitcnt lgkmcnt(4)
    v_mfma_f32_16x16x32_bf16 v[88:91], v[40:43], a[20:23], v[88:91]
    ds_read_b64_tr_b16 v[32:33], v8 offset:20480
    v_mfma_f32_16x16x32_bf16 v[96:99], v[40:43], a[24:27], v[96:99]
    ds_read_b64_tr_b16 v[34:35], v8 offset:20992
    v_mfma_f32_16x16x32_bf16 v[104:107], v[40:43], a[28:31], v[104:107]
    ds_read_b64 a[68:69], v214 offset:24576
    ds_read_b128 a[4:7], v16 offset:2048
    v_mfma_f32_16x16x32_bf16 v[112:115], v[40:43], a[32:35], v[112:115]
    ds_read_b64 a[70:71], v215 offset:24576
    v_mfma_f32_16x16x32_bf16 v[120:123], v[40:43], a[36:39], v[120:123]
    s_waitcnt lgkmcnt(6)
    v_mfma_f32_16x16x32_bf16 v[92:95], v[44:47], a[20:23], v[92:95]
    ds_read_b64_tr_b16 v[36:37], v9 offset:20480
    v_mfma_f32_16x16x32_bf16 v[100:103], v[44:47], a[24:27], v[100:103]
    ds_read_b64_tr_b16 v[38:39], v9 offset:20992
    v_mfma_f32_16x16x32_bf16 v[108:111], v[44:47], a[28:31], v[108:111]
    s_add_u32 s60, s60, 128
    ds_read_b128 a[8:11], v16 offset:4096
    s_add_u32 m0, s59, 16384
    v_mfma_f32_16x16x32_bf16 v[116:119], v[44:47], a[32:35], v[116:119]
    buffer_load_dwordx4 v4, s[16:19], s60 offen lds
    s_add_u32 m0, s59, 17408
    v_mfma_f32_16x16x32_bf16 v[124:127], v[44:47], a[36:39], v[124:127]
    s_waitcnt lgkmcnt(6)
    buffer_load_dwordx4 v5, s[16:19], s60 offen lds
    v_mfma_f32_16x16x32_bf16 v[128:131], v[32:35], a[20:23], v[128:131]
    ds_read_b64_tr_b16 v[40:41], v10 offset:20480
    v_mfma_f32_16x16x32_bf16 v[136:139], v[32:35], a[24:27], v[136:139]
    s_add_u32 m0, s59, 18432
    ds_read_b64_tr_b16 v[42:43], v10 offset:20992
    v_mfma_f32_16x16x32_bf16 v[144:147], v[32:35], a[28:31], v[144:147]
    buffer_load_dwordx4 v6, s[16:19], s60 offen lds
    s_add_u32 m0, s59, 19456
    v_mfma_f32_16x16x32_bf16 v[152:155], v[32:35], a[32:35], v[152:155]
    buffer_load_dwordx4 v7, s[16:19], s60 offen lds
    v_mfma_f32_16x16x32_bf16 v[160:163], v[32:35], a[36:39], v[160:163]
    s_waitcnt lgkmcnt(3)
    v_mfma_f32_16x16x32_bf16 v[132:135], v[36:39], a[20:23], v[132:135]
    ds_read_b64_tr_b16 v[44:45], v11 offset:20480
    v_mfma_f32_16x16x32_bf16 v[140:143], v[36:39], a[24:27], v[140:143]
    ds_read_b64_tr_b16 v[46:47], v11 offset:20992
    v_mfma_f32_16x16x32_bf16 v[148:151], v[36:39], a[28:31], v[148:151]
    ds_read_b128 a[12:15], v16 offset:6144
    v_mfma_f32_16x16x32_bf16 v[156:159], v[36:39], a[32:35], v[156:159]
    s_add_u32 s60, s61, 2621440
    s_and_b32 s60, s60, 0x3fffff
    s_add_u32 m0, s59, 24576
    v_mfma_f32_16x16x32_bf16 v[164:167], v[36:39], a[36:39], v[164:167]
    s_waitcnt vmcnt(16)
    buffer_load_dwordx4 v4, s[16:19], s60 offen lds
    s_waitcnt lgkmcnt(3)
    v_mfma_f32_16x16x32_bf16 v[168:171], v[40:43], a[20:23], v[168:171]
    ds_read_b64_tr_b16 v[32:33], v8 offset:28672
    v_mfma_f32_16x16x32_bf16 v[176:179], v[40:43], a[24:27], v[176:179]
    ds_read_b64_tr_b16 v[34:35], v8 offset:29184
    v_mfma_f32_16x16x32_bf16 v[184:187], v[40:43], a[28:31], v[184:187]
    s_add_u32 m0, s59, 25600
    ds_read_b128 a[16:19], v16 offset:8192
    v_mfma_f32_16x16x32_bf16 v[192:195], v[40:43], a[32:35], v[192:195]
    buffer_load_dwordx4 v5, s[16:19], s60 offen lds
    s_add_u32 m0, s59, 26624
    v_mfma_f32_16x16x32_bf16 v[200:203], v[40:43], a[36:39], v[200:203]
    s_waitcnt lgkmcnt(4)
    buffer_load_dwordx4 v6, s[16:19], s60 offen lds
    v_mfma_f32_16x16x32_bf16 v[172:175], v[44:47], a[20:23], v[172:175]
    ds_read_b64_tr_b16 v[36:37], v9 offset:28672
    v_mfma_f32_16x16x32_bf16 v[180:183], v[44:47], a[24:27], v[180:183]
    s_add_u32 m0, s59, 27648
    ds_read_b64_tr_b16 v[38:39], v9 offset:29184
    v_mfma_f32_16x16x32_bf16 v[188:191], v[44:47], a[28:31], v[188:191]
    s_add_u32 s64, s63, 6
    buffer_load_dwordx4 v7, s[16:19], s60 offen lds
    s_and_b32 s64, s64, 7
    s_lshl_b32 s64, s64, 7
    s_add_u32 m0, s76, 81920
    s_add_u32 s65, s64, 0
    v_mfma_f32_16x16x32_bf16 v[196:199], v[44:47], a[32:35], v[196:199]
    buffer_load_dwordx4 v18, s[4:7], s65 offen lds
    s_add_u32 m0, s76, 83968
    s_add_u32 s65, s64, 16384
    v_mfma_f32_16x16x32_bf16 v[204:207], v[44:47], a[36:39], v[204:207]
    s_waitcnt lgkmcnt(3)
    buffer_load_dwordx4 v18, s[4:7], s65 offen lds
    s_waitcnt lgkmcnt(2)
    v_xor_b32 v17, 0x14000, v17
    v_mfma_f32_16x16x32_bf16 v[48:51], v[32:35], a[0:3], v[48:51]
    ds_read_b64_tr_b16 v[40:41], v10 offset:28672
    v_mfma_f32_16x16x32_bf16 v[56:59], v[32:35], a[4:7], v[56:59]
    s_add_u32 m0, s76, 86016
    ds_read_b64_tr_b16 v[42:43], v10 offset:29184
    s_add_u32 s65, s64, 32768
    v_mfma_f32_16x16x32_bf16 v[64:67], v[32:35], a[8:11], v[64:67]
    buffer_load_dwordx4 v18, s[4:7], s65 offen lds
    s_add_u32 m0, s76, 88064
    s_add_u32 s65, s64, 49152
    v_mfma_f32_16x16x32_bf16 v[72:75], v[32:35], a[12:15], v[72:75]
    buffer_load_dwordx4 v18, s[4:7], s65 offen lds
    s_add_u32 m0, s76, 90112
    s_add_u32 s65, s64, 65536
    v_mfma_f32_16x16x32_bf16 v[80:83], v[32:35], a[16:19], v[80:83]
    s_waitcnt lgkmcnt(2)
    buffer_load_dwordx4 v18, s[4:7], s65 offen lds
    v_mfma_f32_16x16x32_bf16 v[52:55], v[36:39], a[0:3], v[52:55]
    ds_read_b64_tr_b16 v[44:45], v11 offset:28672
    v_mfma_f32_16x16x32_bf16 v[60:63], v[36:39], a[4:7], v[60:63]
    ds_read_b64_tr_b16 v[46:47], v11 offset:29184
    v_mfma_f32_16x16x32_bf16 v[68:71], v[36:39], a[8:11], v[68:71]
    s_add_u32 m0, s59, 20480
    ds_read_b128 a[20:23], v17 offset:0
    v_mfma_f32_16x16x32_bf16 v[76:79], v[36:39], a[12:15], v[76:79]
    buffer_load_dwordx4 v228, s[8:11], s69 offen offset:0 nt lds
    s_add_u32 m0, s59, 20480
    v_mfma_f32_16x16x32_bf16 v[84:87], v[36:39], a[16:19], v[84:87]
    s_waitcnt vmcnt(22)
    buffer_load_dwordx4 v229, s[8:11], s69 offen offset:1024 nt lds
    s_waitcnt lgkmcnt(3)
    v_mfma_f32_16x16x32_bf16 v[88:91], v[40:43], a[0:3], v[88:91]
    ds_read_b64_tr_b16 v[32:33], v8 offset:12288
    v_mfma_f32_16x16x32_bf16 v[96:99], v[40:43], a[4:7], v[96:99]
    s_waitcnt vmcnt(19)
    ds_read_b64_tr_b16 v[34:35], v8 offset:12800
    v_mfma_f32_16x16x32_bf16 v[104:107], v[40:43], a[8:11], v[104:107]
    s_add_u32 m0, s59, 20480
    ds_read_b64 a[72:73], v208 offset:32768
    ds_read_b128 a[24:27], v17 offset:2048
    v_mfma_f32_16x16x32_bf16 v[112:115], v[40:43], a[12:15], v[112:115]
    buffer_load_dwordx4 v230, s[8:11], s69 offen offset:2048 nt lds
    ds_read_b64 a[74:75], v209 offset:32768
    s_add_u32 m0, s59, 20480
    v_mfma_f32_16x16x32_bf16 v[120:123], v[40:43], a[16:19], v[120:123]
    s_waitcnt lgkmcnt(6)
    buffer_load_dwordx4 v231, s[8:11], s69 offen offset:3072 nt lds
    ds_read_b64 a[76:77], v210 offset:32768
    v_mfma_f32_16x16x32_bf16 v[92:95], v[44:47], a[0:3], v[92:95]
    ds_read_b64 a[78:79], v211 offset:32768
    ds_read_b64_tr_b16 v[36:37], v9 offset:12288
    v_mfma_f32_16x16x32_bf16 v[100:103], v[44:47], a[4:7], v[100:103]
    ds_read_b64 a[80:81], v212 offset:32768
    ds_read_b64_tr_b16 v[38:39], v9 offset:12800
    v_mfma_f32_16x16x32_bf16 v[108:111], v[44:47], a[8:11], v[108:111]
    ds_read_b64 a[82:83], v213 offset:32768
    ds_read_b128 a[28:31], v17 offset:4096
    v_mfma_f32_16x16x32_bf16 v[116:119], v[44:47], a[12:15], v[116:119]
    ds_read_b64 a[84:85], v214 offset:32768
    v_mfma_f32_16x16x32_bf16 v[124:127], v[44:47], a[16:19], v[124:127]
    s_waitcnt lgkmcnt(11)
    ds_read_b64 a[86:87], v215 offset:32768
    v_mfma_f32_16x16x32_bf16 v[128:131], v[32:35], a[0:3], v[128:131]
    ds_read_b64_tr_b16 v[40:41], v10 offset:12288
    v_mfma_f32_16x16x32_bf16 v[136:139], v[32:35], a[4:7], v[136:139]
    ds_read_b64_tr_b16 v[42:43], v10 offset:12800
    v_mfma_f32_16x16x32_bf16 v[144:147], v[32:35], a[8:11], v[144:147]
    v_mfma_f32_16x16x32_bf16 v[152:155], v[32:35], a[12:15], v[152:155]
    v_mfma_f32_16x16x32_bf16 v[160:163], v[32:35], a[16:19], v[160:163]
    s_waitcnt lgkmcnt(6)
    v_mfma_f32_16x16x32_bf16 v[132:135], v[36:39], a[0:3], v[132:135]
    ds_read_b64_tr_b16 v[44:45], v11 offset:12288
    v_mfma_f32_16x16x32_bf16 v[140:143], v[36:39], a[4:7], v[140:143]
    ds_read_b64_tr_b16 v[46:47], v11 offset:12800
    v_mfma_f32_16x16x32_bf16 v[148:151], v[36:39], a[8:11], v[148:151]
    s_add_u32 s60, s60, 128
    ds_read_b128 a[32:35], v17 offset:6144
    s_add_u32 m0, s59, 28672
    v_mfma_f32_16x16x32_bf16 v[156:159], v[36:39], a[12:15], v[156:159]
    buffer_load_dwordx4 v4, s[16:19], s60 offen lds
    s_add_u32 m0, s59, 29696
    v_mfma_f32_16x16x32_bf16 v[164:167], v[36:39], a[16:19], v[164:167]
    s_waitcnt vmcnt(18)
    buffer_load_dwordx4 v5, s[16:19], s60 offen lds
    s_waitcnt lgkmcnt(3)
    v_mfma_f32_16x16x32_bf16 v[168:171], v[40:43], a[0:3], v[168:171]
    ds_read_b64_tr_b16 v[32:33], v8 offset:36864
    v_mfma_f32_16x16x32_bf16 v[176:179], v[40:43], a[4:7], v[176:179]
    ds_read_b64_tr_b16 v[34:35], v8 offset:37376
    v_mfma_f32_16x16x32_bf16 v[184:187], v[40:43], a[8:11], v[184:187]
    s_add_u32 m0, s59, 30720
    ds_read_b128 a[36:39], v17 offset:8192
    v_mfma_f32_16x16x32_bf16 v[192:195], v[40:43], a[12:15], v[192:195]
    buffer_load_dwordx4 v6, s[16:19], s60 offen lds
    s_add_u32 m0, s59, 31744
    v_mfma_f32_16x16x32_bf16 v[200:203], v[40:43], a[16:19], v[200:203]
    s_waitcnt lgkmcnt(4)
    buffer_load_dwordx4 v7, s[16:19], s60 offen lds
    v_mfma_f32_16x16x32_bf16 v[172:175], v[44:47], a[0:3], v[172:175]
    ds_read_b64_tr_b16 v[36:37], v9 offset:36864
    v_mfma_f32_16x16x32_bf16 v[180:183], v[44:47], a[4:7], v[180:183]
    ds_read_b64_tr_b16 v[38:39], v9 offset:37376
    v_mfma_f32_16x16x32_bf16 v[188:191], v[44:47], a[8:11], v[188:191]
    v_mfma_f32_16x16x32_bf16 v[196:199], v[44:47], a[12:15], v[196:199]
    v_mfma_f32_16x16x32_bf16 v[204:207], v[44:47], a[16:19], v[204:207]
    s_waitcnt lgkmcnt(3)
    s_waitcnt lgkmcnt(2)
    v_mfma_f32_16x16x32_bf16 v[48:51], v[32:35], a[20:23], v[48:51]
    ds_read_b64_tr_b16 v[40:41], v10 offset:36864
    v_mfma_f32_16x16x32_bf16 v[56:59], v[32:35], a[24:27], v[56:59]
    s_add_u32 s60, s62, 2883584
    ds_read_b64_tr_b16 v[42:43], v10 offset:37376
    s_and_b32 s60, s60, 0x3fffff
    s_add_u32 m0, s59, 32768
    v_mfma_f32_16x16x32_bf16 v[64:67], v[32:35], a[28:31], v[64:67]
    buffer_load_dwordx4 v4, s[16:19], s60 offen lds
    s_add_u32 m0, s59, 33792
    v_mfma_f32_16x16x32_bf16 v[72:75], v[32:35], a[32:35], v[72:75]
    buffer_load_dwordx4 v5, s[16:19], s60 offen lds
    s_add_u32 m0, s59, 34816
    v_mfma_f32_16x16x32_bf16 v[80:83], v[32:35], a[36:39], v[80:83]
    s_waitcnt lgkmcnt(2)
    buffer_load_dwordx4 v6, s[16:19], s60 offen lds
    v_mfma_f32_16x16x32_bf16 v[52:55], v[36:39], a[20:23], v[52:55]
    ds_read_b64_tr_b16 v[44:45], v11 offset:36864
    v_mfma_f32_16x16x32_bf16 v[60:63], v[36:39], a[24:27], v[60:63]
    ds_read_b64_tr_b16 v[46:47], v11 offset:37376
    v_mfma_f32_16x16x32_bf16 v[68:71], v[36:39], a[28:31], v[68:71]
    s_add_u32 m0, s59, 35840
    ds_read_b128 a[0:3], v16 offset:40960
    v_mfma_f32_16x16x32_bf16 v[76:79], v[36:39], a[32:35], v[76:79]
    buffer_load_dwordx4 v7, s[16:19], s60 offen lds
    v_mfma_f32_16x16x32_bf16 v[84:87], v[36:39], a[36:39], v[84:87]
    s_waitcnt vmcnt(21)
    s_waitcnt lgkmcnt(3)
    v_mfma_f32_16x16x32_bf16 v[88:91], v[40:43], a[20:23], v[88:91]
    ds_read_b64_tr_b16 v[32:33], v8 offset:16384
    v_mfma_f32_16x16x32_bf16 v[96:99], v[40:43], a[24:27], v[96:99]
    ds_read_b64_tr_b16 v[34:35], v8 offset:16896
    v_mfma_f32_16x16x32_bf16 v[104:107], v[40:43], a[28:31], v[104:107]
    ds_read_b128 a[4:7], v16 offset:43008
    v_mfma_f32_16x16x32_bf16 v[112:115], v[40:43], a[32:35], v[112:115]
    s_add_u32 s60, s60, 128
    s_add_u32 m0, s59, 12288
    v_mfma_f32_16x16x32_bf16 v[120:123], v[40:43], a[36:39], v[120:123]
    s_waitcnt lgkmcnt(4)
    buffer_load_dwordx4 v4, s[16:19], s60 offen lds
    v_mfma_f32_16x16x32_bf16 v[92:95], v[44:47], a[20:23], v[92:95]
    ds_read_b64_tr_b16 v[36:37], v9 offset:16384
    v_mfma_f32_16x16x32_bf16 v[100:103], v[44:47], a[24:27], v[100:103]
    ds_read_b64_tr_b16 v[38:39], v9 offset:16896
    v_mfma_f32_16x16x32_bf16 v[108:111], v[44:47], a[28:31], v[108:111]
    s_add_u32 m0, s59, 13312
    ds_read_b128 a[8:11], v16 offset:45056
    v_mfma_f32_16x16x32_bf16 v[116:119], v[44:47], a[32:35], v[116:119]
    buffer_load_dwordx4 v5, s[16:19], s60 offen lds
    s_add_u32 m0, s59, 14336
    v_mfma_f32_16x16x32_bf16 v[124:127], v[44:47], a[36:39], v[124:127]
    s_waitcnt lgkmcnt(4)
    buffer_load_dwordx4 v6, s[16:19], s60 offen lds
    v_mfma_f32_16x16x32_bf16 v[128:131], v[32:35], a[20:23], v[128:131]
    ds_read_b64_tr_b16 v[40:41], v10 offset:16384
    v_mfma_f32_16x16x32_bf16 v[136:139], v[32:35], a[24:27], v[136:139]
    s_add_u32 m0, s59, 15360
    ds_read_b64_tr_b16 v[42:43], v10 offset:16896
    v_mfma_f32_16x16x32_bf16 v[144:147], v[32:35], a[28:31], v[144:147]
    buffer_load_dwordx4 v7, s[16:19], s60 offen lds
    s_add_u32 m0, s59, 36864
    v_mfma_f32_16x16x32_bf16 v[152:155], v[32:35], a[32:35], v[152:155]
    buffer_load_dwordx4 v228, s[8:11], s70 offen offset:0 nt lds
    s_add_u32 m0, s59, 36864
    v_mfma_f32_16x16x32_bf16 v[160:163], v[32:35], a[36:39], v[160:163]
    s_waitcnt lgkmcnt(3)
    buffer_load_dwordx4 v229, s[8:11], s70 offen offset:1024 nt lds
    v_mfma_f32_16x16x32_bf16 v[132:135], v[36:39], a[20:23], v[132:135]
    ds_read_b64_tr_b16 v[44:45], v11 offset:16384
    v_mfma_f32_16x16x32_bf16 v[140:143], v[36:39], a[24:27], v[140:143]
    ds_read_b64_tr_b16 v[46:47], v11 offset:16896
    v_mfma_f32_16x16x32_bf16 v[148:151], v[36:39], a[28:31], v[148:151]
    s_add_u32 m0, s59, 36864
    ds_read_b128 a[12:15], v16 offset:47104
    v_mfma_f32_16x16x32_bf16 v[156:159], v[36:39], a[32:35], v[156:159]
    buffer_load_dwordx4 v230, s[8:11], s70 offen offset:2048 nt lds
    s_add_u32 m0, s59, 36864
    v_mfma_f32_16x16x32_bf16 v[164:167], v[36:39], a[36:39], v[164:167]
    s_waitcnt vmcnt(24)
    buffer_load_dwordx4 v231, s[8:11], s70 offen offset:3072 nt lds
    s_waitcnt lgkmcnt(3)
    v_mfma_f32_16x16x32_bf16 v[168:171], v[40:43], a[20:23], v[168:171]
    ds_read_b64_tr_b16 v[32:33], v8 offset:24576
    v_xor_b32 v228, 128, v22
    v_mfma_f32_16x16x32_bf16 v[176:179], v[40:43], a[24:27], v[176:179]
    ds_read_b64_tr_b16 v[34:35], v8 offset:25088
    v_xor_b32 v229, 160, v22
    v_mfma_f32_16x16x32_bf16 v[184:187], v[40:43], a[28:31], v[184:187]
    s_waitcnt vmcnt(16)
    ds_read_b128 a[16:19], v16 offset:49152
    v_xor_b32 v230, 192, v22
    v_mfma_f32_16x16x32_bf16 v[192:195], v[40:43], a[32:35], v[192:195]
    ds_read_b64 a[88:89], v208 offset:20480
    v_xor_b32 v231, 224, v22
    v_mfma_f32_16x16x32_bf16 v[200:203], v[40:43], a[36:39], v[200:203]
    s_waitcnt lgkmcnt(5)
    ds_read_b64 a[90:91], v209 offset:20480
    v_mfma_f32_16x16x32_bf16 v[172:175], v[44:47], a[20:23], v[172:175]
    ds_read_b64_tr_b16 v[36:37], v9 offset:24576
    v_mfma_f32_16x16x32_bf16 v[180:183], v[44:47], a[24:27], v[180:183]
    ds_read_b64_tr_b16 v[38:39], v9 offset:25088
    v_mfma_f32_16x16x32_bf16 v[188:191], v[44:47], a[28:31], v[188:191]
    ds_read_b64 a[92:93], v210 offset:20480
    v_mfma_f32_16x16x32_bf16 v[196:199], v[44:47], a[32:35], v[196:199]
    ds_read_b64 a[94:95], v211 offset:20480
    v_mfma_f32_16x16x32_bf16 v[204:207], v[44:47], a[36:39], v[204:207]
    s_waitcnt lgkmcnt(7)
    ds_read_b64 a[96:97], v212 offset:20480
    s_waitcnt lgkmcnt(7)
    v_mfma_f32_16x16x32_bf16 v[48:51], v[32:35], a[0:3], v[48:51]
    s_mul_i32 s47, s55, 163840
    ds_read_b64_tr_b16 v[40:41], v10 offset:24576
    s_lshl_b32 s99, s57, 10
    v_mfma_f32_16x16x32_bf16 v[56:59], v[32:35], a[4:7], v[56:59]
    s_add_u32 s47, s47, s99
    ds_read_b64_tr_b16 v[42:43], v10 offset:25088
    s_lshl_b32 s99, s56, 7
    v_mfma_f32_16x16x32_bf16 v[64:67], v[32:35], a[8:11], v[64:67]
    s_add_u32 s60, s61, 3145728
    ds_read_b64 a[98:99], v213 offset:20480
    s_and_b32 s60, s60, 0x3fffff
    s_add_u32 m0, s59, 16384
    v_mfma_f32_16x16x32_bf16 v[72:75], v[32:35], a[12:15], v[72:75]
    ds_read_b64 a[100:101], v214 offset:20480
    buffer_load_dwordx4 v4, s[16:19], s60 offen lds
    s_add_u32 m0, s59, 17408
    v_mfma_f32_16x16x32_bf16 v[80:83], v[32:35], a[16:19], v[80:83]
    s_waitcnt lgkmcnt(7)
    ds_read_b64 a[102:103], v215 offset:20480
    buffer_load_dwordx4 v5, s[16:19], s60 offen lds
    v_mfma_f32_16x16x32_bf16 v[52:55], v[36:39], a[0:3], v[52:55]
    s_add_u32 s47, s47, s99
    ds_read_b64_tr_b16 v[44:45], v11 offset:24576
    s_lshl_b32 s99, s54, 5
    v_mfma_f32_16x16x32_bf16 v[60:63], v[36:39], a[4:7], v[60:63]
    s_add_u32 s47, s47, s99
    ds_read_b64_tr_b16 v[46:47], v11 offset:25088
    v_mfma_f32_16x16x32_bf16 v[68:71], v[36:39], a[8:11], v[68:71]
    s_add_u32 m0, s59, 18432
    ds_read_b128 a[20:23], v17 offset:40960
    v_mfma_f32_16x16x32_bf16 v[76:79], v[36:39], a[12:15], v[76:79]
    buffer_load_dwordx4 v6, s[16:19], s60 offen lds
    s_add_u32 m0, s59, 19456
    v_mfma_f32_16x16x32_bf16 v[84:87], v[36:39], a[16:19], v[84:87]
    s_waitcnt vmcnt(15)
    buffer_load_dwordx4 v7, s[16:19], s60 offen lds
    s_waitcnt lgkmcnt(6)
    v_mfma_f32_16x16x32_bf16 v[88:91], v[40:43], a[0:3], v[88:91]
    ds_read_b64_tr_b16 v[32:33], v8 offset:28672
    v_mfma_f32_16x16x32_bf16 v[96:99], v[40:43], a[4:7], v[96:99]
    ds_read_b64_tr_b16 v[34:35], v8 offset:29184
    v_mfma_f32_16x16x32_bf16 v[104:107], v[40:43], a[8:11], v[104:107]
    ds_read_b128 a[24:27], v17 offset:43008
    v_mfma_f32_16x16x32_bf16 v[112:115], v[40:43], a[12:15], v[112:115]
    v_mfma_f32_16x16x32_bf16 v[120:123], v[40:43], a[16:19], v[120:123]
    s_waitcnt lgkmcnt(4)
    v_mfma_f32_16x16x32_bf16 v[92:95], v[44:47], a[0:3], v[92:95]
    ds_read_b64_tr_b16 v[36:37], v9 offset:28672
    v_mfma_f32_16x16x32_bf16 v[100:103], v[44:47], a[4:7], v[100:103]
    ds_read_b64_tr_b16 v[38:39], v9 offset:29184
    v_mfma_f32_16x16x32_bf16 v[108:111], v[44:47], a[8:11], v[108:111]
    s_add_u32 s60, s60, 128
    ds_read_b128 a[28:31], v17 offset:45056
    s_add_u32 m0, s59, 24576
    v_mfma_f32_16x16x32_bf16 v[116:119], v[44:47], a[12:15], v[116:119]
    buffer_load_dwordx4 v4, s[16:19], s60 offen lds
    s_add_u32 m0, s59, 25600
    v_mfma_f32_16x16x32_bf16 v[124:127], v[44:47], a[16:19], v[124:127]
    s_waitcnt lgkmcnt(4)
    buffer_load_dwordx4 v5, s[16:19], s60 offen lds
    v_mfma_f32_16x16x32_bf16 v[128:131], v[32:35], a[0:3], v[128:131]
    ds_read_b64_tr_b16 v[40:41], v10 offset:28672
    v_mfma_f32_16x16x32_bf16 v[136:139], v[32:35], a[4:7], v[136:139]
    s_add_u32 m0, s59, 26624
    ds_read_b64_tr_b16 v[42:43], v10 offset:29184
    v_mfma_f32_16x16x32_bf16 v[144:147], v[32:35], a[8:11], v[144:147]
    buffer_load_dwordx4 v6, s[16:19], s60 offen lds
    s_add_u32 m0, s59, 27648
    v_mfma_f32_16x16x32_bf16 v[152:155], v[32:35], a[12:15], v[152:155]
    buffer_load_dwordx4 v7, s[16:19], s60 offen lds
    v_mfma_f32_16x16x32_bf16 v[160:163], v[32:35], a[16:19], v[160:163]
    s_waitcnt lgkmcnt(3)
    v_mfma_f32_16x16x32_bf16 v[132:135], v[36:39], a[0:3], v[132:135]
    ds_read_b64_tr_b16 v[44:45], v11 offset:28672
    v_mfma_f32_16x16x32_bf16 v[140:143], v[36:39], a[4:7], v[140:143]
    ds_read_b64_tr_b16 v[46:47], v11 offset:29184
    v_mfma_f32_16x16x32_bf16 v[148:151], v[36:39], a[8:11], v[148:151]
    ds_read_b128 a[32:35], v17 offset:47104
    v_mfma_f32_16x16x32_bf16 v[156:159], v[36:39], a[12:15], v[156:159]
    s_add_u32 s60, s62, 3407872
    s_and_b32 s60, s60, 0x3fffff
    s_add_u32 m0, s59, 20480
    v_mfma_f32_16x16x32_bf16 v[164:167], v[36:39], a[16:19], v[164:167]
    s_waitcnt vmcnt(16)
    buffer_load_dwordx4 v4, s[16:19], s60 offen lds
    s_waitcnt lgkmcnt(3)
    v_mfma_f32_16x16x32_bf16 v[168:171], v[40:43], a[0:3], v[168:171]
    ds_read_b64_tr_b16 v[32:33], v8 offset:32768
    v_mfma_f32_16x16x32_bf16 v[176:179], v[40:43], a[4:7], v[176:179]
    ds_read_b64_tr_b16 v[34:35], v8 offset:33280
    v_mfma_f32_16x16x32_bf16 v[184:187], v[40:43], a[8:11], v[184:187]
    s_add_u32 m0, s59, 21504
    ds_read_b128 a[36:39], v17 offset:49152
    v_mfma_f32_16x16x32_bf16 v[192:195], v[40:43], a[12:15], v[192:195]
    buffer_load_dwordx4 v5, s[16:19], s60 offen lds
    s_add_u32 m0, s59, 22528
    v_mfma_f32_16x16x32_bf16 v[200:203], v[40:43], a[16:19], v[200:203]
    s_waitcnt lgkmcnt(4)
    buffer_load_dwordx4 v6, s[16:19], s60 offen lds
    v_mfma_f32_16x16x32_bf16 v[172:175], v[44:47], a[0:3], v[172:175]
    ds_read_b64_tr_b16 v[36:37], v9 offset:32768
    v_mfma_f32_16x16x32_bf16 v[180:183], v[44:47], a[4:7], v[180:183]
    s_add_u32 m0, s59, 23552
    ds_read_b64_tr_b16 v[38:39], v9 offset:33280
    v_mfma_f32_16x16x32_bf16 v[188:191], v[44:47], a[8:11], v[188:191]
    buffer_load_dwordx4 v7, s[16:19], s60 offen lds
    v_mfma_f32_16x16x32_bf16 v[196:199], v[44:47], a[12:15], v[196:199]
    s_waitcnt vmcnt(12)
    v_mfma_f32_16x16x32_bf16 v[204:207], v[44:47], a[16:19], v[204:207]
    s_waitcnt lgkmcnt(3)
    ds_read_b64 a[104:105], v208 offset:36864
    s_waitcnt lgkmcnt(3)
    s_barrier
    v_xor_b32 v16, 0x14000, v16
    v_mfma_f32_16x16x32_bf16 v[48:51], v[32:35], a[20:23], v[48:51]
    s_lshl_b32 s99, s54, 5
    ds_read_b64_tr_b16 v[40:41], v10 offset:32768
    s_add_u32 s71, s75, s99
    v_mfma_f32_16x16x32_bf16 v[56:59], v[32:35], a[24:27], v[56:59]
    s_add_u32 s60, s60, 128
    ds_read_b64_tr_b16 v[42:43], v10 offset:33280
    s_add_u32 m0, s59, 28672
    v_mfma_f32_16x16x32_bf16 v[64:67], v[32:35], a[28:31], v[64:67]
    s_lshl_b32 s99, s58, 3
    buffer_load_dwordx4 v4, s[16:19], s60 offen lds
    s_add_u32 m0, s59, 29696
    v_mfma_f32_16x16x32_bf16 v[72:75], v[32:35], a[32:35], v[72:75]
    s_add_u32 s99, s99, s56
    buffer_load_dwordx4 v5, s[16:19], s60 offen lds
    s_add_u32 m0, s59, 30720
    v_mfma_f32_16x16x32_bf16 v[80:83], v[32:35], a[36:39], v[80:83]
    s_waitcnt lgkmcnt(3)
    buffer_load_dwordx4 v6, s[16:19], s60 offen lds
    s_mul_i32 s72, s99, 81920
    v_mfma_f32_16x16x32_bf16 v[52:55], v[36:39], a[20:23], v[52:55]
    s_mul_i32 s99, s54, 2560
    ds_read_b64_tr_b16 v[44:45], v11 offset:32768
    s_add_u32 s72, s72, s99
    v_mfma_f32_16x16x32_bf16 v[60:63], v[36:39], a[24:27], v[60:63]
    s_add_u32 s98, s72, 71680
    ds_read_b64_tr_b16 v[46:47], v11 offset:33280
    v_mfma_f32_16x16x32_bf16 v[68:71], v[36:39], a[28:31], v[68:71]
    s_add_u32 m0, s59, 31744
    ds_read_b128 a[0:3], v16 offset:0
    v_mfma_f32_16x16x32_bf16 v[76:79], v[36:39], a[32:35], v[76:79]
    buffer_load_dwordx4 v7, s[16:19], s60 offen lds
    v_mfma_f32_16x16x32_bf16 v[84:87], v[36:39], a[36:39], v[84:87]
    ds_read_b64 a[106:107], v209 offset:36864
    s_waitcnt lgkmcnt(4)
    v_mfma_f32_16x16x32_bf16 v[88:91], v[40:43], a[20:23], v[88:91]
    ds_read_b64_tr_b16 v[32:33], v8 offset:12288
    v_mfma_f32_16x16x32_bf16 v[96:99], v[40:43], a[24:27], v[96:99]
    ds_read_b64_tr_b16 v[34:35], v8 offset:12800
    v_mfma_f32_16x16x32_bf16 v[104:107], v[40:43], a[28:31], v[104:107]
    ds_read_b128 a[4:7], v16 offset:2048
    v_mfma_f32_16x16x32_bf16 v[112:115], v[40:43], a[32:35], v[112:115]
    ds_read_b64 a[108:109], v210 offset:36864
    v_mfma_f32_16x16x32_bf16 v[120:123], v[40:43], a[36:39], v[120:123]
    s_waitcnt lgkmcnt(6)
    ds_read_b64 a[110:111], v211 offset:36864
    v_mfma_f32_16x16x32_bf16 v[92:95], v[44:47], a[20:23], v[92:95]
    ds_read_b64_tr_b16 v[36:37], v9 offset:12288
    v_mfma_f32_16x16x32_bf16 v[100:103], v[44:47], a[24:27], v[100:103]
    ds_read_b64 a[112:113], v212 offset:36864
    ds_read_b64_tr_b16 v[38:39], v9 offset:12800
    v_mfma_f32_16x16x32_bf16 v[108:111], v[44:47], a[28:31], v[108:111]
    s_add_u32 s60, s61, 3670016
    ds_read_b64 a[114:115], v213 offset:36864
    s_and_b32 s60, s60, 0x3fffff
    s_add_u32 m0, s59, 32768
    ds_read_b128 a[8:11], v16 offset:4096
    v_mfma_f32_16x16x32_bf16 v[116:119], v[44:47], a[32:35], v[116:119]
    ds_read_b64 a[116:117], v214 offset:36864
    buffer_load_dwordx4 v4, s[16:19], s60 offen lds
    s_add_u32 m0, s59, 33792
    v_mfma_f32_16x16x32_bf16 v[124:127], v[44:47], a[36:39], v[124:127]
    s_waitcnt lgkmcnt(9)
    ds_read_b64 a[118:119], v215 offset:36864
    buffer_load_dwordx4 v5, s[16:19], s60 offen lds
    v_mfma_f32_16x16x32_bf16 v[128:131], v[32:35], a[20:23], v[128:131]
    ds_read_b64_tr_b16 v[40:41], v10 offset:12288
    v_mfma_f32_16x16x32_bf16 v[136:139], v[32:35], a[24:27], v[136:139]
    s_add_u32 m0, s59, 34816
    ds_read_b64_tr_b16 v[42:43], v10 offset:12800
    v_mfma_f32_16x16x32_bf16 v[144:147], v[32:35], a[28:31], v[144:147]
    buffer_load_dwordx4 v6, s[16:19], s60 offen lds
    s_add_u32 m0, s59, 35840
    v_mfma_f32_16x16x32_bf16 v[152:155], v[32:35], a[32:35], v[152:155]
    buffer_load_dwordx4 v7, s[16:19], s60 offen lds
    v_mfma_f32_16x16x32_bf16 v[160:163], v[32:35], a[36:39], v[160:163]
    s_waitcnt lgkmcnt(6)
    v_mfma_f32_16x16x32_bf16 v[132:135], v[36:39], a[20:23], v[132:135]
    ds_read_b64_tr_b16 v[44:45], v11 offset:12288
    v_mfma_f32_16x16x32_bf16 v[140:143], v[36:39], a[24:27], v[140:143]
    ds_read_b64_tr_b16 v[46:47], v11 offset:12800
    v_mfma_f32_16x16x32_bf16 v[148:151], v[36:39], a[28:31], v[148:151]
    ds_read_b128 a[12:15], v16 offset:6144
    v_mfma_f32_16x16x32_bf16 v[156:159], v[36:39], a[32:35], v[156:159]
    v_mfma_f32_16x16x32_bf16 v[164:167], v[36:39], a[36:39], v[164:167]
    s_waitcnt vmcnt(16)
    s_waitcnt lgkmcnt(3)
    v_mfma_f32_16x16x32_bf16 v[168:171], v[40:43], a[20:23], v[168:171]
    ds_read_b64_tr_b16 v[32:33], v8 offset:16384
    v_mfma_f32_16x16x32_bf16 v[176:179], v[40:43], a[24:27], v[176:179]
    ds_read_b64_tr_b16 v[34:35], v8 offset:16896
    v_mfma_f32_16x16x32_bf16 v[184:187], v[40:43], a[28:31], v[184:187]
    ds_read_b128 a[16:19], v16 offset:8192
    v_mfma_f32_16x16x32_bf16 v[192:195], v[40:43], a[32:35], v[192:195]
    v_mfma_f32_16x16x32_bf16 v[200:203], v[40:43], a[36:39], v[200:203]
    s_waitcnt lgkmcnt(4)
    v_mfma_f32_16x16x32_bf16 v[172:175], v[44:47], a[20:23], v[172:175]
    ds_read_b64_tr_b16 v[36:37], v9 offset:16384
    v_mfma_f32_16x16x32_bf16 v[180:183], v[44:47], a[24:27], v[180:183]
    s_add_u32 s60, s60, 128
    ds_read_b64_tr_b16 v[38:39], v9 offset:16896
    s_add_u32 m0, s59, 36864
    v_mfma_f32_16x16x32_bf16 v[188:191], v[44:47], a[28:31], v[188:191]
    buffer_load_dwordx4 v4, s[16:19], s60 offen lds
    s_add_u32 m0, s59, 37888
    v_mfma_f32_16x16x32_bf16 v[196:199], v[44:47], a[32:35], v[196:199]
    buffer_load_dwordx4 v5, s[16:19], s60 offen lds
    s_add_u32 m0, s59, 38912
    v_mfma_f32_16x16x32_bf16 v[204:207], v[44:47], a[36:39], v[204:207]
    s_waitcnt lgkmcnt(3)
    buffer_load_dwordx4 v6, s[16:19], s60 offen lds
    s_waitcnt lgkmcnt(2)
    v_xor_b32 v17, 0x14000, v17
    v_mfma_f32_16x16x32_bf16 v[48:51], v[32:35], a[0:3], v[48:51]
    ds_read_b64_tr_b16 v[40:41], v10 offset:16384
    v_mfma_f32_16x16x32_bf16 v[56:59], v[32:35], a[4:7], v[56:59]
    s_add_u32 m0, s59, 39936
    ds_read_b64_tr_b16 v[42:43], v10 offset:16896
    v_mfma_f32_16x16x32_bf16 v[64:67], v[32:35], a[8:11], v[64:67]
    buffer_load_dwordx4 v7, s[16:19], s60 offen lds
    v_mfma_f32_16x16x32_bf16 v[72:75], v[32:35], a[12:15], v[72:75]
    v_mfma_f32_16x16x32_bf16 v[80:83], v[32:35], a[16:19], v[80:83]
    s_waitcnt lgkmcnt(2)
    v_mfma_f32_16x16x32_bf16 v[52:55], v[36:39], a[0:3], v[52:55]
    ds_read_b64_tr_b16 v[44:45], v11 offset:16384
    v_mfma_f32_16x16x32_bf16 v[60:63], v[36:39], a[4:7], v[60:63]
    ds_read_b64_tr_b16 v[46:47], v11 offset:16896
    v_mfma_f32_16x16x32_bf16 v[68:71], v[36:39], a[8:11], v[68:71]
    s_add_u32 s60, s62, 3932160
    ds_read_b128 a[20:23], v17 offset:0
    s_and_b32 s60, s60, 0x3fffff
    s_add_u32 m0, s59, 12288
    v_mfma_f32_16x16x32_bf16 v[76:79], v[36:39], a[12:15], v[76:79]
    buffer_load_dwordx4 v4, s[16:19], s60 offen lds
    s_add_u32 m0, s59, 13312
    v_mfma_f32_16x16x32_bf16 v[84:87], v[36:39], a[16:19], v[84:87]
    s_waitcnt vmcnt(17)
    buffer_load_dwordx4 v5, s[16:19], s60 offen lds
    s_waitcnt lgkmcnt(3)
    v_mfma_f32_16x16x32_bf16 v[88:91], v[40:43], a[0:3], v[88:91]
    ds_read_b64_tr_b16 v[32:33], v8 offset:24576
    v_mfma_f32_16x16x32_bf16 v[96:99], v[40:43], a[4:7], v[96:99]
    ds_read_b64_tr_b16 v[34:35], v8 offset:25088
    v_mfma_f32_16x16x32_bf16 v[104:107], v[40:43], a[8:11], v[104:107]
    s_add_u32 m0, s59, 14336
    ds_read_b128 a[24:27], v17 offset:2048
    v_mfma_f32_16x16x32_bf16 v[112:115], v[40:43], a[12:15], v[112:115]
    buffer_load_dwordx4 v6, s[16:19], s60 offen lds
    s_add_u32 m0, s59, 15360
    v_mfma_f32_16x16x32_bf16 v[120:123], v[40:43], a[16:19], v[120:123]
    s_waitcnt lgkmcnt(4)
    buffer_load_dwordx4 v7, s[16:19], s60 offen lds
    v_mfma_f32_16x16x32_bf16 v[92:95], v[44:47], a[0:3], v[92:95]
    ds_read_b64_tr_b16 v[36:37], v9 offset:24576
    v_mfma_f32_16x16x32_bf16 v[100:103], v[44:47], a[4:7], v[100:103]
    ds_read_b64_tr_b16 v[38:39], v9 offset:25088
    v_mfma_f32_16x16x32_bf16 v[108:111], v[44:47], a[8:11], v[108:111]
    ds_read_b128 a[28:31], v17 offset:4096
    v_mfma_f32_16x16x32_bf16 v[116:119], v[44:47], a[12:15], v[116:119]
    v_mfma_f32_16x16x32_bf16 v[124:127], v[44:47], a[16:19], v[124:127]
    s_waitcnt lgkmcnt(4)
    v_mfma_f32_16x16x32_bf16 v[128:131], v[32:35], a[0:3], v[128:131]
    ds_read_b64_tr_b16 v[40:41], v10 offset:24576
    v_mfma_f32_16x16x32_bf16 v[136:139], v[32:35], a[4:7], v[136:139]
    s_add_u32 s60, s60, 128
    ds_read_b64_tr_b16 v[42:43], v10 offset:25088
    s_add_u32 m0, s59, 16384
    v_mfma_f32_16x16x32_bf16 v[144:147], v[32:35], a[8:11], v[144:147]
    buffer_load_dwordx4 v4, s[16:19], s60 offen lds
    s_add_u32 m0, s59, 17408
    v_mfma_f32_16x16x32_bf16 v[152:155], v[32:35], a[12:15], v[152:155]
    buffer_load_dwordx4 v5, s[16:19], s60 offen lds
    s_add_u32 m0, s59, 18432
    v_mfma_f32_16x16x32_bf16 v[160:163], v[32:35], a[16:19], v[160:163]
    s_waitcnt lgkmcnt(3)
    buffer_load_dwordx4 v6, s[16:19], s60 offen lds
    v_mfma_f32_16x16x32_bf16 v[132:135], v[36:39], a[0:3], v[132:135]
    ds_read_b64_tr_b16 v[44:45], v11 offset:24576
    v_mfma_f32_16x16x32_bf16 v[140:143], v[36:39], a[4:7], v[140:143]
    ds_read_b64_tr_b16 v[46:47], v11 offset:25088
    v_mfma_f32_16x16x32_bf16 v[148:151], v[36:39], a[8:11], v[148:151]
    s_add_u32 m0, s59, 19456
    ds_read_b128 a[32:35], v17 offset:6144
    v_mfma_f32_16x16x32_bf16 v[156:159], v[36:39], a[12:15], v[156:159]
    buffer_load_dwordx4 v7, s[16:19], s60 offen lds
    v_mfma_f32_16x16x32_bf16 v[164:167], v[36:39], a[16:19], v[164:167]
    s_waitcnt vmcnt(20)
    s_waitcnt lgkmcnt(3)
    buffer_store_dword v244, v251, s[24:27], s75 offen sc1
    v_mfma_f32_16x16x32_bf16 v[168:171], v[40:43], a[0:3], v[168:171]
    s_lshr_b32 s96, s54, 0
    ds_read_b64_tr_b16 v[32:33], v8 offset:20480
    v_mfma_f32_16x16x32_bf16 v[176:179], v[40:43], a[4:7], v[176:179]
    s_add_u32 s96, s96, s56
    ds_read_b64_tr_b16 v[34:35], v8 offset:20992
    v_mfma_f32_16x16x32_bf16 v[184:187], v[40:43], a[8:11], v[184:187]
    s_add_u32 s96, s96, 1
    ds_read_b128 a[36:39], v17 offset:8192
    v_mfma_f32_16x16x32_bf16 v[192:195], v[40:43], a[12:15], v[192:195]
    s_and_b32 s96, s96, 7
    v_mfma_f32_16x16x32_bf16 v[200:203], v[40:43], a[16:19], v[200:203]
    s_waitcnt lgkmcnt(4)
    v_mfma_f32_16x16x32_bf16 v[172:175], v[44:47], a[0:3], v[172:175]
    s_lshl_b32 s96, s96, 7
    ds_read_b64_tr_b16 v[36:37], v9 offset:20480
    v_mfma_f32_16x16x32_bf16 v[180:183], v[44:47], a[4:7], v[180:183]
    s_add_u32 m0, s59, 24576
    ds_read_b64_tr_b16 v[38:39], v9 offset:20992
    v_mfma_f32_16x16x32_bf16 v[188:191], v[44:47], a[8:11], v[188:191]
    buffer_load_dwordx4 v20, s[12:15], 0 offen offset:0 nt lds
    s_add_u32 m0, s59, 24576
    v_mfma_f32_16x16x32_bf16 v[196:199], v[44:47], a[12:15], v[196:199]
    buffer_load_dwordx4 v21, s[12:15], 0 offen offset:1024 nt lds
    s_add_u32 m0, s59, 24576
    v_mfma_f32_16x16x32_bf16 v[204:207], v[44:47], a[16:19], v[204:207]
    s_waitcnt lgkmcnt(3)
    buffer_load_dwordx4 v20, s[12:15], 0 offen offset:2048 nt lds
    s_waitcnt lgkmcnt(2)
    v_mfma_f32_16x16x32_bf16 v[48:51], v[32:35], a[20:23], v[48:51]
    s_xor_b32 s61, s54, 0
    ds_read_b64_tr_b16 v[40:41], v10 offset:20480
    v_mfma_f32_16x16x32_bf16 v[56:59], v[32:35], a[24:27], v[56:59]
    s_add_u32 m0, s59, 24576
    ds_read_b64_tr_b16 v[42:43], v10 offset:20992
    v_mfma_f32_16x16x32_bf16 v[64:67], v[32:35], a[28:31], v[64:67]
    s_lshl_b32 s61, s61, 17
    buffer_load_dwordx4 v21, s[12:15], 0 offen offset:3072 nt lds
    v_mfma_f32_16x16x32_bf16 v[72:75], v[32:35], a[32:35], v[72:75]
    s_add_u32 s61, s61, s96
    v_mfma_f32_16x16x32_bf16 v[80:83], v[32:35], a[36:39], v[80:83]
    s_waitcnt lgkmcnt(2)
    v_mfma_f32_16x16x32_bf16 v[52:55], v[36:39], a[20:23], v[52:55]
    s_xor_b32 s62, s54, 1
    ds_read_b64_tr_b16 v[44:45], v11 offset:20480
    v_mfma_f32_16x16x32_bf16 v[60:63], v[36:39], a[24:27], v[60:63]
    s_lshl_b32 s62, s62, 17
    ds_read_b64_tr_b16 v[46:47], v11 offset:20992
    v_mfma_f32_16x16x32_bf16 v[68:71], v[36:39], a[28:31], v[68:71]
    s_add_u32 s62, s62, s96
    ds_read_b128 a[0:3], v16 offset:40960
    v_mfma_f32_16x16x32_bf16 v[76:79], v[36:39], a[32:35], v[76:79]
    s_xor_b32 s63, s54, 2
    v_mfma_f32_16x16x32_bf16 v[84:87], v[36:39], a[36:39], v[84:87]
    s_waitcnt vmcnt(21)
    s_waitcnt lgkmcnt(3)
    v_mfma_f32_16x16x32_bf16 v[88:91], v[40:43], a[20:23], v[88:91]
    s_lshl_b32 s63, s63, 17
    ds_read_b64_tr_b16 v[32:33], v8 offset:28672
    v_mfma_f32_16x16x32_bf16 v[96:99], v[40:43], a[24:27], v[96:99]
    s_add_u32 s63, s63, s96
    ds_read_b64_tr_b16 v[34:35], v8 offset:29184
    v_mfma_f32_16x16x32_bf16 v[104:107], v[40:43], a[28:31], v[104:107]
    s_xor_b32 s64, s54, 3
    ds_read_b128 a[4:7], v16 offset:43008
    v_mfma_f32_16x16x32_bf16 v[112:115], v[40:43], a[32:35], v[112:115]
    s_lshl_b32 s64, s64, 17
    v_mfma_f32_16x16x32_bf16 v[120:123], v[40:43], a[36:39], v[120:123]
    s_waitcnt lgkmcnt(4)
    v_mfma_f32_16x16x32_bf16 v[92:95], v[44:47], a[20:23], v[92:95]
    s_add_u32 s64, s64, s96
    ds_read_b64_tr_b16 v[36:37], v9 offset:28672
    v_lshrrev_b32 v5, 3, v1
    v_mfma_f32_16x16x32_bf16 v[100:103], v[44:47], a[24:27], v[100:103]
    ds_read_b64_tr_b16 v[38:39], v9 offset:29184
    v_lshlrev_b32 v6, 1, v2
    v_mfma_f32_16x16x32_bf16 v[108:111], v[44:47], a[28:31], v[108:111]
    s_add_u32 m0, s59, 20480
    ds_read_b128 a[8:11], v16 offset:45056
    v_and_b32 v4, 7, v1
    v_mfma_f32_16x16x32_bf16 v[116:119], v[44:47], a[32:35], v[116:119]
    buffer_load_dwordx4 v20, s[12:15], s67 offen offset:0 nt lds
    s_add_u32 m0, s59, 20480
    v_xor_b32 v4, v4, v6
    v_mfma_f32_16x16x32_bf16 v[124:127], v[44:47], a[36:39], v[124:127]
    s_waitcnt lgkmcnt(4)
    buffer_load_dwordx4 v21, s[12:15], s67 offen offset:1024 nt lds
    v_lshlrev_b32 v4, 4, v4
    v_mfma_f32_16x16x32_bf16 v[128:131], v[32:35], a[20:23], v[128:131]
    ds_read_b64_tr_b16 v[40:41], v10 offset:28672
    v_lshl_add_u32 v4, v5, 10, v4
    v_mfma_f32_16x16x32_bf16 v[136:139], v[32:35], a[24:27], v[136:139]
    s_add_u32 m0, s59, 20480
    ds_read_b64_tr_b16 v[42:43], v10 offset:29184
    v_add_u32 v5, 8192, v4
    v_mfma_f32_16x16x32_bf16 v[144:147], v[32:35], a[28:31], v[144:147]
    buffer_load_dwordx4 v20, s[12:15], s67 offen offset:2048 nt lds
    s_add_u32 m0, s59, 20480
    v_add_u32 v6, 16384, v4
    v_mfma_f32_16x16x32_bf16 v[152:155], v[32:35], a[32:35], v[152:155]
    buffer_load_dwordx4 v21, s[12:15], s67 offen offset:3072 nt lds
    v_add_u32 v7, 24576, v4
    v_mfma_f32_16x16x32_bf16 v[160:163], v[32:35], a[36:39], v[160:163]
    s_waitcnt lgkmcnt(3)
    v_mfma_f32_16x16x32_bf16 v[132:135], v[36:39], a[20:23], v[132:135]
    ds_read_b64_tr_b16 v[44:45], v11 offset:28672
    v_mfma_f32_16x16x32_bf16 v[140:143], v[36:39], a[24:27], v[140:143]
    ds_read_b64_tr_b16 v[46:47], v11 offset:29184
    v_mfma_f32_16x16x32_bf16 v[148:151], v[36:39], a[28:31], v[148:151]
    ds_read_b128 a[12:15], v16 offset:47104
    v_mfma_f32_16x16x32_bf16 v[156:159], v[36:39], a[32:35], v[156:159]
    v_mfma_f32_16x16x32_bf16 v[164:167], v[36:39], a[36:39], v[164:167]
    s_waitcnt vmcnt(21)
    s_waitcnt lgkmcnt(3)
    v_mfma_f32_16x16x32_bf16 v[168:171], v[40:43], a[20:23], v[168:171]
    ds_read_b64_tr_b16 v[32:33], v8 offset:32768
    v_mfma_f32_16x16x32_bf16 v[176:179], v[40:43], a[24:27], v[176:179]
    ds_read_b64_tr_b16 v[34:35], v8 offset:33280
    v_mfma_f32_16x16x32_bf16 v[184:187], v[40:43], a[28:31], v[184:187]
    ds_read_b128 a[16:19], v16 offset:49152
    v_mfma_f32_16x16x32_bf16 v[192:195], v[40:43], a[32:35], v[192:195]
    v_mfma_f32_16x16x32_bf16 v[200:203], v[40:43], a[36:39], v[200:203]
    s_waitcnt lgkmcnt(4)
    v_mfma_f32_16x16x32_bf16 v[172:175], v[44:47], a[20:23], v[172:175]
    ds_read_b64_tr_b16 v[36:37], v9 offset:32768
    v_mfma_f32_16x16x32_bf16 v[180:183], v[44:47], a[24:27], v[180:183]
    ds_read_b64_tr_b16 v[38:39], v9 offset:33280
    v_mfma_f32_16x16x32_bf16 v[188:191], v[44:47], a[28:31], v[188:191]
    v_mfma_f32_16x16x32_bf16 v[196:199], v[44:47], a[32:35], v[196:199]
    v_mfma_f32_16x16x32_bf16 v[204:207], v[44:47], a[36:39], v[204:207]
    s_waitcnt lgkmcnt(3)
    s_waitcnt lgkmcnt(2)
    v_mfma_f32_16x16x32_bf16 v[48:51], v[32:35], a[0:3], v[48:51]
    ds_read_b64_tr_b16 v[40:41], v10 offset:32768
    v_mfma_f32_16x16x32_bf16 v[56:59], v[32:35], a[4:7], v[56:59]
    ds_read_b64_tr_b16 v[42:43], v10 offset:33280
    v_mfma_f32_16x16x32_bf16 v[64:67], v[32:35], a[8:11], v[64:67]
    v_mfma_f32_16x16x32_bf16 v[72:75], v[32:35], a[12:15], v[72:75]
    v_mfma_f32_16x16x32_bf16 v[80:83], v[32:35], a[16:19], v[80:83]
    s_waitcnt lgkmcnt(2)
    v_mfma_f32_16x16x32_bf16 v[52:55], v[36:39], a[0:3], v[52:55]
    ds_read_b64_tr_b16 v[44:45], v11 offset:32768
    v_mfma_f32_16x16x32_bf16 v[60:63], v[36:39], a[4:7], v[60:63]
    ds_read_b64_tr_b16 v[46:47], v11 offset:33280
    v_mfma_f32_16x16x32_bf16 v[68:71], v[36:39], a[8:11], v[68:71]
    ds_read_b128 a[20:23], v17 offset:40960
    v_mfma_f32_16x16x32_bf16 v[76:79], v[36:39], a[12:15], v[76:79]
    v_mfma_f32_16x16x32_bf16 v[84:87], v[36:39], a[16:19], v[84:87]
    s_waitcnt vmcnt(17)
    s_waitcnt lgkmcnt(3)
    v_mfma_f32_16x16x32_bf16 v[88:91], v[40:43], a[0:3], v[88:91]
    ds_read_b64_tr_b16 v[32:33], v8 offset:36864
    v_mfma_f32_16x16x32_bf16 v[96:99], v[40:43], a[4:7], v[96:99]
    ds_read_b64_tr_b16 v[34:35], v8 offset:37376
    v_mfma_f32_16x16x32_bf16 v[104:107], v[40:43], a[8:11], v[104:107]
    ds_read_b128 a[24:27], v17 offset:43008
    v_mfma_f32_16x16x32_bf16 v[112:115], v[40:43], a[12:15], v[112:115]
    v_mfma_f32_16x16x32_bf16 v[120:123], v[40:43], a[16:19], v[120:123]
    s_waitcnt lgkmcnt(4)
    v_mfma_f32_16x16x32_bf16 v[92:95], v[44:47], a[0:3], v[92:95]
    ds_read_b64_tr_b16 v[36:37], v9 offset:36864
    v_mfma_f32_16x16x32_bf16 v[100:103], v[44:47], a[4:7], v[100:103]
    ds_read_b64_tr_b16 v[38:39], v9 offset:37376
    v_mfma_f32_16x16x32_bf16 v[108:111], v[44:47], a[8:11], v[108:111]
    ds_read_b128 a[28:31], v17 offset:45056
    v_mfma_f32_16x16x32_bf16 v[116:119], v[44:47], a[12:15], v[116:119]
    v_mfma_f32_16x16x32_bf16 v[124:127], v[44:47], a[16:19], v[124:127]
    s_waitcnt lgkmcnt(4)
    v_mfma_f32_16x16x32_bf16 v[128:131], v[32:35], a[0:3], v[128:131]
    ds_read_b64_tr_b16 v[40:41], v10 offset:36864
    v_mfma_f32_16x16x32_bf16 v[136:139], v[32:35], a[4:7], v[136:139]
    s_waitcnt vmcnt(4)
    ds_read_b64_tr_b16 v[42:43], v10 offset:37376
    v_mfma_f32_16x16x32_bf16 v[144:147], v[32:35], a[8:11], v[144:147]
    ds_read_b64_tr_b16 a[120:121], v22 offset:24576
    v_mfma_f32_16x16x32_bf16 v[152:155], v[32:35], a[12:15], v[152:155]
    ds_read_b64_tr_b16 a[130:131], v23 offset:24576
    v_mfma_f32_16x16x32_bf16 v[160:163], v[32:35], a[16:19], v[160:163]
    s_waitcnt lgkmcnt(5)
    ds_read_b64_tr_b16 a[140:141], v24 offset:24576
    v_mfma_f32_16x16x32_bf16 v[132:135], v[36:39], a[0:3], v[132:135]
    ds_read_b64_tr_b16 v[44:45], v11 offset:36864
    v_mfma_f32_16x16x32_bf16 v[140:143], v[36:39], a[4:7], v[140:143]
    ds_read_b64_tr_b16 v[46:47], v11 offset:37376
    v_mfma_f32_16x16x32_bf16 v[148:151], v[36:39], a[8:11], v[148:151]
    ds_read_b128 a[32:35], v17 offset:47104
    v_mfma_f32_16x16x32_bf16 v[156:159], v[36:39], a[12:15], v[156:159]
    ds_read_b64_tr_b16 a[150:151], v19 offset:24576
    v_mfma_f32_16x16x32_bf16 v[164:167], v[36:39], a[16:19], v[164:167]
    ds_read_b64_tr_b16 a[160:161], v228 offset:24576
    s_waitcnt lgkmcnt(8)
    v_mfma_f32_16x16x32_bf16 v[168:171], v[40:43], a[0:3], v[168:171]
    ds_read_b64_tr_b16 v[32:33], v8 offset:12288
    v_mfma_f32_16x16x32_bf16 v[176:179], v[40:43], a[4:7], v[176:179]
    ds_read_b64_tr_b16 v[34:35], v8 offset:12800
    v_mfma_f32_16x16x32_bf16 v[184:187], v[40:43], a[8:11], v[184:187]
    s_add_u32 m0, s59, 28672
    ds_read_b128 a[36:39], v17 offset:49152
    v_mfma_f32_16x16x32_bf16 v[192:195], v[40:43], a[12:15], v[192:195]
    buffer_load_dwordx4 v20, s[12:15], s68 offen offset:0 nt lds
    v_mfma_f32_16x16x32_bf16 v[200:203], v[40:43], a[16:19], v[200:203]
    s_waitcnt lgkmcnt(6)
    ds_read_b64_tr_b16 a[170:171], v229 offset:24576
    v_mfma_f32_16x16x32_bf16 v[172:175], v[44:47], a[0:3], v[172:175]
    ds_read_b64_tr_b16 v[36:37], v9 offset:12288
    v_mfma_f32_16x16x32_bf16 v[180:183], v[44:47], a[4:7], v[180:183]
    s_add_u32 m0, s59, 28672
    ds_read_b64_tr_b16 v[38:39], v9 offset:12800
    v_mfma_f32_16x16x32_bf16 v[188:191], v[44:47], a[8:11], v[188:191]
    buffer_load_dwordx4 v21, s[12:15], s68 offen offset:1024 nt lds
    v_mfma_f32_16x16x32_bf16 v[196:199], v[44:47], a[12:15], v[196:199]
    ds_read_b64_tr_b16 a[180:181], v230 offset:24576
    v_mfma_f32_16x16x32_bf16 v[204:207], v[44:47], a[16:19], v[204:207]
    s_waitcnt lgkmcnt(5)
    ds_read_b64_tr_b16 a[190:191], v231 offset:24576
    s_waitcnt lgkmcnt(5)
    s_barrier
    v_mfma_f32_16x16x32_bf16 v[48:51], v[32:35], a[20:23], v[48:51]
    ds_read_b64_tr_b16 v[40:41], v10 offset:12288
    v_mfma_f32_16x16x32_bf16 v[56:59], v[32:35], a[24:27], v[56:59]
    s_add_u32 m0, s59, 28672
    ds_read_b64_tr_b16 v[42:43], v10 offset:12800
    v_mfma_f32_16x16x32_bf16 v[64:67], v[32:35], a[28:31], v[64:67]
    s_waitcnt vmcnt(2)
    buffer_load_dwordx4 v20, s[12:15], s68 offen offset:2048 nt lds
    v_mfma_f32_16x16x32_bf16 v[72:75], v[32:35], a[32:35], v[72:75]
    ds_read_b64_tr_b16 a[122:123], v22 offset:20480
    v_mfma_f32_16x16x32_bf16 v[80:83], v[32:35], a[36:39], v[80:83]
    s_waitcnt lgkmcnt(5)
    ds_read_b64_tr_b16 a[132:133], v23 offset:20480
    v_mfma_f32_16x16x32_bf16 v[52:55], v[36:39], a[20:23], v[52:55]
    ds_read_b64_tr_b16 v[44:45], v11 offset:12288
    v_mfma_f32_16x16x32_bf16 v[60:63], v[36:39], a[24:27], v[60:63]
    s_add_u32 m0, s59, 28672
    ds_read_b64_tr_b16 v[46:47], v11 offset:12800
    v_mfma_f32_16x16x32_bf16 v[68:71], v[36:39], a[28:31], v[68:71]
    buffer_load_dwordx4 v21, s[12:15], s68 offen offset:3072 nt lds
    v_mfma_f32_16x16x32_bf16 v[76:79], v[36:39], a[32:35], v[76:79]
    ds_read_b64_tr_b16 a[142:143], v24 offset:20480
    v_mfma_f32_16x16x32_bf16 v[84:87], v[36:39], a[36:39], v[84:87]
    ds_read_b64_tr_b16 a[152:153], v19 offset:20480
    s_waitcnt lgkmcnt(6)
    v_mfma_f32_16x16x32_bf16 v[88:91], v[40:43], a[20:23], v[88:91]
    ds_read_b64_tr_b16 v[32:33], v8 offset:16384
    v_cvt_pk_bf16_f32 v48, v48, v49
    v_mfma_f32_16x16x32_bf16 v[96:99], v[40:43], a[24:27], v[96:99]
    ds_read_b64_tr_b16 v[34:35], v8 offset:16896
    v_cvt_pk_bf16_f32 v49, v50, v51
    v_mfma_f32_16x16x32_bf16 v[104:107], v[40:43], a[28:31], v[104:107]
    ds_read_b64_tr_b16 a[162:163], v228 offset:20480
    v_cvt_pk_bf16_f32 v50, v52, v53
    v_mfma_f32_16x16x32_bf16 v[112:115], v[40:43], a[32:35], v[112:115]
    ds_read_b64_tr_b16 a[172:173], v229 offset:20480
    v_cvt_pk_bf16_f32 v51, v54, v55
    v_mfma_f32_16x16x32_bf16 v[120:123], v[40:43], a[36:39], v[120:123]
    s_waitcnt lgkmcnt(6)
    ds_read_b64_tr_b16 a[182:183], v230 offset:20480
    v_cvt_pk_bf16_f32 v56, v56, v57
    v_mfma_f32_16x16x32_bf16 v[92:95], v[44:47], a[20:23], v[92:95]
    ds_read_b64_tr_b16 v[36:37], v9 offset:16384
    v_cvt_pk_bf16_f32 v57, v58, v59
    v_mfma_f32_16x16x32_bf16 v[100:103], v[44:47], a[24:27], v[100:103]
    ds_read_b64_tr_b16 v[38:39], v9 offset:16896
    v_cvt_pk_bf16_f32 v58, v60, v61
    v_mfma_f32_16x16x32_bf16 v[108:111], v[44:47], a[28:31], v[108:111]
    ds_read_b64_tr_b16 a[192:193], v231 offset:20480
    v_cvt_pk_bf16_f32 v59, v62, v63
    v_mfma_f32_16x16x32_bf16 v[116:119], v[44:47], a[32:35], v[116:119]
    buffer_atomic_add v247, v246, s[32:35], 0 offen sc1
    v_cvt_pk_bf16_f32 v64, v64, v65
    v_mfma_f32_16x16x32_bf16 v[124:127], v[44:47], a[36:39], v[124:127]
    s_waitcnt lgkmcnt(6)
    v_cvt_pk_bf16_f32 v65, v66, v67
    v_cvt_pk_bf16_f32 v66, v68, v69
    v_mfma_f32_16x16x32_bf16 v[128:131], v[32:35], a[20:23], v[128:131]
    ds_read_b64_tr_b16 v[40:41], v10 offset:16384
    v_cvt_pk_bf16_f32 v67, v70, v71
    v_mfma_f32_16x16x32_bf16 v[136:139], v[32:35], a[24:27], v[136:139]
    ds_read_b64_tr_b16 v[42:43], v10 offset:16896
    v_cvt_pk_bf16_f32 v72, v72, v73
    v_mfma_f32_16x16x32_bf16 v[144:147], v[32:35], a[28:31], v[144:147]
    v_cvt_pk_bf16_f32 v73, v74, v75
    v_cvt_pk_bf16_f32 v74, v76, v77
    v_mfma_f32_16x16x32_bf16 v[152:155], v[32:35], a[32:35], v[152:155]
    v_cvt_pk_bf16_f32 v75, v78, v79
    v_cvt_pk_bf16_f32 v80, v80, v81
    v_mfma_f32_16x16x32_bf16 v[160:163], v[32:35], a[36:39], v[160:163]
    s_waitcnt lgkmcnt(3)
    v_cvt_pk_bf16_f32 v81, v82, v83
    v_cvt_pk_bf16_f32 v82, v84, v85
    v_mfma_f32_16x16x32_bf16 v[132:135], v[36:39], a[20:23], v[132:135]
    ds_read_b64_tr_b16 v[44:45], v11 offset:16384
    v_cvt_pk_bf16_f32 v83, v86, v87
    v_mfma_f32_16x16x32_bf16 v[140:143], v[36:39], a[24:27], v[140:143]
    ds_read_b64_tr_b16 v[46:47], v11 offset:16896
    v_cvt_pk_bf16_f32 v88, v88, v89
    v_mfma_f32_16x16x32_bf16 v[148:151], v[36:39], a[28:31], v[148:151]
    v_cvt_pk_bf16_f32 v89, v90, v91
    v_cvt_pk_bf16_f32 v90, v92, v93
    v_mfma_f32_16x16x32_bf16 v[156:159], v[36:39], a[32:35], v[156:159]
    v_cvt_pk_bf16_f32 v91, v94, v95
    v_cvt_pk_bf16_f32 v96, v96, v97
    v_mfma_f32_16x16x32_bf16 v[164:167], v[36:39], a[36:39], v[164:167]
    s_waitcnt lgkmcnt(2)
    v_cvt_pk_bf16_f32 v97, v98, v99
    v_cvt_pk_bf16_f32 v98, v100, v101
    v_mfma_f32_16x16x32_bf16 v[168:171], v[40:43], a[20:23], v[168:171]
    v_cvt_pk_bf16_f32 v99, v102, v103
    v_cvt_pk_bf16_f32 v104, v104, v105
    v_mfma_f32_16x16x32_bf16 v[176:179], v[40:43], a[24:27], v[176:179]
    v_cvt_pk_bf16_f32 v105, v106, v107
    v_cvt_pk_bf16_f32 v106, v108, v109
    v_mfma_f32_16x16x32_bf16 v[184:187], v[40:43], a[28:31], v[184:187]
    v_cvt_pk_bf16_f32 v107, v110, v111
    v_cvt_pk_bf16_f32 v112, v112, v113
    v_mfma_f32_16x16x32_bf16 v[192:195], v[40:43], a[32:35], v[192:195]
    v_cvt_pk_bf16_f32 v113, v114, v115
    v_cvt_pk_bf16_f32 v114, v116, v117
    v_mfma_f32_16x16x32_bf16 v[200:203], v[40:43], a[36:39], v[200:203]
    s_waitcnt lgkmcnt(0)
    v_cvt_pk_bf16_f32 v115, v118, v119
    v_cvt_pk_bf16_f32 v120, v120, v121
    v_mfma_f32_16x16x32_bf16 v[172:175], v[44:47], a[20:23], v[172:175]
    v_cvt_pk_bf16_f32 v121, v122, v123
    v_cvt_pk_bf16_f32 v122, v124, v125
    v_mfma_f32_16x16x32_bf16 v[180:183], v[44:47], a[24:27], v[180:183]
    v_cvt_pk_bf16_f32 v123, v126, v127
    v_cvt_pk_bf16_f32 v128, v128, v129
    v_mfma_f32_16x16x32_bf16 v[188:191], v[44:47], a[28:31], v[188:191]
    v_cvt_pk_bf16_f32 v129, v130, v131
    v_cvt_pk_bf16_f32 v130, v132, v133
    v_mfma_f32_16x16x32_bf16 v[196:199], v[44:47], a[32:35], v[196:199]
    v_cvt_pk_bf16_f32 v131, v134, v135
    v_mfma_f32_16x16x32_bf16 v[204:207], v[44:47], a[36:39], v[204:207]
    v_cvt_pk_bf16_f32 v168, v168, v169
    v_cvt_pk_bf16_f32 v169, v170, v171
    v_mfma_f32_16x16x32_bf16 v[208:211], a[40:43], v[48:51], 0
    v_cvt_pk_bf16_f32 v170, v172, v173
    v_cvt_pk_bf16_f32 v171, v174, v175
    v_mfma_f32_16x16x32_bf16 v[212:215], a[56:59], v[48:51], 0
    v_cvt_pk_bf16_f32 v136, v136, v137
    v_cvt_pk_bf16_f32 v137, v138, v139
    v_mfma_f32_16x16x32_bf16 v[216:219], a[72:75], v[48:51], 0
    v_cvt_pk_bf16_f32 v138, v140, v141
    v_cvt_pk_bf16_f32 v139, v142, v143
    v_mfma_f32_16x16x32_bf16 v[220:223], a[88:91], v[48:51], 0
    v_cvt_pk_bf16_f32 v176, v176, v177
    v_cvt_pk_bf16_f32 v177, v178, v179
    v_mfma_f32_16x16x32_bf16 v[224:227], a[104:107], v[48:51], 0
    v_cvt_pk_bf16_f32 v178, v180, v181
    v_cvt_pk_bf16_f32 v179, v182, v183
    v_mfma_f32_16x16x32_bf16 v[208:211], a[44:47], v[88:91], v[208:211]
    v_cvt_pk_bf16_f32 v144, v144, v145
    v_cvt_pk_bf16_f32 v145, v146, v147
    v_mfma_f32_16x16x32_bf16 v[212:215], a[60:63], v[88:91], v[212:215]
    v_cvt_pk_bf16_f32 v146, v148, v149
    v_cvt_pk_bf16_f32 v147, v150, v151
    v_mfma_f32_16x16x32_bf16 v[216:219], a[76:79], v[88:91], v[216:219]
    s_add_u32 m0, s59, 32768
    v_cvt_pk_bf16_f32 v184, v184, v185
    v_cvt_pk_bf16_f32 v185, v186, v187
    v_mfma_f32_16x16x32_bf16 v[220:223], a[92:95], v[88:91], v[220:223]
    buffer_load_dwordx4 v20, s[12:15], s69 offen offset:0 nt lds
    v_cvt_pk_bf16_f32 v186, v188, v189
    v_mfma_f32_16x16x32_bf16 v[224:227], a[108:111], v[88:91], v[224:227]
    v_cvt_pk_bf16_f32 v187, v190, v191
    v_cvt_pk_bf16_f32 v152, v152, v153
    v_mfma_f32_16x16x32_bf16 v[208:211], a[48:51], v[128:131], v[208:211]
    s_add_u32 m0, s59, 32768
    v_cvt_pk_bf16_f32 v153, v154, v155
    v_cvt_pk_bf16_f32 v154, v156, v157
    v_mfma_f32_16x16x32_bf16 v[212:215], a[64:67], v[128:131], v[212:215]
    buffer_load_dwordx4 v21, s[12:15], s69 offen offset:1024 nt lds
    v_cvt_pk_bf16_f32 v155, v158, v159
    v_mfma_f32_16x16x32_bf16 v[216:219], a[80:83], v[128:131], v[216:219]
    v_cvt_pk_bf16_f32 v192, v192, v193
    v_cvt_pk_bf16_f32 v193, v194, v195
    v_mfma_f32_16x16x32_bf16 v[220:223], a[96:99], v[128:131], v[220:223]
    s_add_u32 m0, s59, 32768
    v_cvt_pk_bf16_f32 v194, v196, v197
    v_cvt_pk_bf16_f32 v195, v198, v199
    v_mfma_f32_16x16x32_bf16 v[224:227], a[112:115], v[128:131], v[224:227]
    buffer_load_dwordx4 v20, s[12:15], s69 offen offset:2048 nt lds
    v_cvt_pk_bf16_f32 v160, v160, v161
    v_mfma_f32_16x16x32_bf16 v[208:211], a[52:55], v[168:171], v[208:211]
    v_cvt_pk_bf16_f32 v161, v162, v163
    v_cvt_pk_bf16_f32 v162, v164, v165
    v_mfma_f32_16x16x32_bf16 v[212:215], a[68:71], v[168:171], v[212:215]
    s_add_u32 m0, s59, 32768
    v_cvt_pk_bf16_f32 v163, v166, v167
    v_cvt_pk_bf16_f32 v200, v200, v201
    v_mfma_f32_16x16x32_bf16 v[216:219], a[84:87], v[168:171], v[216:219]
    buffer_load_dwordx4 v21, s[12:15], s69 offen offset:3072 nt lds
    v_cvt_pk_bf16_f32 v201, v202, v203
    v_mfma_f32_16x16x32_bf16 v[220:223], a[100:103], v[168:171], v[220:223]
    v_cvt_pk_bf16_f32 v202, v204, v205
    v_cvt_pk_bf16_f32 v203, v206, v207
    v_mfma_f32_16x16x32_bf16 v[224:227], a[116:119], v[168:171], v[224:227]
    v_max3_f32 v240, v208, v209, v210
    v_max3_f32 v240, v240, v211, v212
    v_mfma_f32_16x16x32_bf16 v[52:55], a[40:43], v[56:59], 0
    v_max3_f32 v240, v240, v213, v214
    v_max3_f32 v240, v240, v215, v216
    v_mfma_f32_16x16x32_bf16 v[60:63], a[56:59], v[56:59], 0
    v_max3_f32 v240, v240, v217, v218
    v_max3_f32 v240, v240, v219, v220
    v_mfma_f32_16x16x32_bf16 v[68:71], a[72:75], v[56:59], 0
    v_max3_f32 v240, v240, v221, v222
    v_max3_f32 v240, v240, v223, v224
    v_mfma_f32_16x16x32_bf16 v[76:79], a[88:91], v[56:59], 0
    v_max3_f32 v240, v240, v225, v226
    v_max_f32 v240, v240, v227
    v_mfma_f32_16x16x32_bf16 v[84:87], a[104:107], v[56:59], 0
    v_mov_b32 v241, v240
    v_mfma_f32_16x16x32_bf16 v[52:55], a[44:47], v[96:99], v[52:55]
    s_nop 0
    v_permlane32_swap_b32 v241, v240
    v_mfma_f32_16x16x32_bf16 v[60:63], a[60:63], v[96:99], v[60:63]
    v_max_f32 v240, v240, v241
    v_mov_b32 v241, v240
    v_mfma_f32_16x16x32_bf16 v[68:71], a[76:79], v[96:99], v[68:71]
    s_nop 0
    v_permlane16_swap_b32 v241, v240
    v_mfma_f32_16x16x32_bf16 v[76:79], a[92:95], v[96:99], v[76:79]
    v_max_f32 v240, v240, v241
    v_mul_f32 v240, s66, v240
    v_mfma_f32_16x16x32_bf16 v[84:87], a[108:111], v[96:99], v[84:87]
    v_fma_f32 v208, v208, s66, -v240
    v_fma_f32 v209, v209, s66, -v240
    v_mfma_f32_16x16x32_bf16 v[52:55], a[48:51], v[136:139], v[52:55]
    v_fma_f32 v210, v210, s66, -v240
    v_fma_f32 v211, v211, s66, -v240
    v_mfma_f32_16x16x32_bf16 v[60:63], a[64:67], v[136:139], v[60:63]
    v_exp_f32 v208, v208
    v_mfma_f32_16x16x32_bf16 v[68:71], a[80:83], v[136:139], v[68:71]
    v_exp_f32 v209, v209
    v_mfma_f32_16x16x32_bf16 v[76:79], a[96:99], v[136:139], v[76:79]
    v_fma_f32 v212, v212, s66, -v240
    v_fma_f32 v213, v213, s66, -v240
    v_mfma_f32_16x16x32_bf16 v[84:87], a[112:115], v[136:139], v[84:87]
    v_exp_f32 v210, v210
    v_mfma_f32_16x16x32_bf16 v[52:55], a[52:55], v[176:179], v[52:55]
    v_exp_f32 v211, v211
    v_mfma_f32_16x16x32_bf16 v[60:63], a[68:71], v[176:179], v[60:63]
    v_cvt_pk_bf16_f32 v48, v208, v209
    v_fma_f32 v214, v214, s66, -v240
    v_mfma_f32_16x16x32_bf16 v[68:71], a[84:87], v[176:179], v[68:71]
    v_fma_f32 v215, v215, s66, -v240
    v_cvt_pk_bf16_f32 v49, v210, v211
    v_mfma_f32_16x16x32_bf16 v[76:79], a[100:103], v[176:179], v[76:79]
    v_exp_f32 v212, v212
    v_mfma_f32_16x16x32_bf16 v[84:87], a[116:119], v[176:179], v[84:87]
    v_exp_f32 v213, v213
    v_fma_f32 v216, v216, s66, -v240
    v_fma_f32 v217, v217, s66, -v240
    v_exp_f32 v214, v214
    v_exp_f32 v215, v215
    v_cvt_pk_bf16_f32 v50, v212, v213
    v_pk_fma_f32 v[218:219], v[218:219], s[66:67], v[240:241] op_sel_hi:[1,0,0] neg_lo:[0,0,1] neg_hi:[0,0,1]
    v_exp_f32 v216, v216
    v_exp_f32 v217, v217
    v_cvt_pk_bf16_f32 v51, v214, v215
    v_pk_fma_f32 v[220:221], v[220:221], s[66:67], v[240:241] op_sel_hi:[1,0,0] neg_lo:[0,0,1] neg_hi:[0,0,1]
    v_exp_f32 v218, v218
    v_exp_f32 v219, v219
    v_cvt_pk_bf16_f32 v88, v216, v217
    v_pk_fma_f32 v[222:223], v[222:223], s[66:67], v[240:241] op_sel_hi:[1,0,0] neg_lo:[0,0,1] neg_hi:[0,0,1]
    v_exp_f32 v220, v220
    v_exp_f32 v221, v221
    v_cvt_pk_bf16_f32 v89, v218, v219
    v_pk_fma_f32 v[224:225], v[224:225], s[66:67], v[240:241] op_sel_hi:[1,0,0] neg_lo:[0,0,1] neg_hi:[0,0,1]
    v_exp_f32 v222, v222
    v_exp_f32 v223, v223
    v_cvt_pk_bf16_f32 v90, v220, v221
    v_pk_fma_f32 v[226:227], v[226:227], s[66:67], v[240:241] op_sel_hi:[1,0,0] neg_lo:[0,0,1] neg_hi:[0,0,1]
    v_exp_f32 v224, v224
    v_exp_f32 v225, v225
    v_cvt_pk_bf16_f32 v91, v222, v223
    v_exp_f32 v226, v226
    v_exp_f32 v227, v227
    v_cvt_pk_bf16_f32 v128, v224, v225
    v_cvt_pk_bf16_f32 v129, v226, v227
    v_mfma_f32_16x16x32_bf16 v[208:211], a[40:43], v[64:67], 0
    v_max3_f32 v240, v52, v53, v54
    v_max3_f32 v240, v240, v55, v60
    v_mfma_f32_16x16x32_bf16 v[212:215], a[56:59], v[64:67], 0
    v_max3_f32 v240, v240, v61, v62
    v_max3_f32 v240, v240, v63, v68
    v_mfma_f32_16x16x32_bf16 v[216:219], a[72:75], v[64:67], 0
    v_max3_f32 v240, v240, v69, v70
    v_max3_f32 v240, v240, v71, v76
    v_mfma_f32_16x16x32_bf16 v[220:223], a[88:91], v[64:67], 0
    v_max3_f32 v240, v240, v77, v78
    v_max3_f32 v240, v240, v79, v84
    v_mfma_f32_16x16x32_bf16 v[224:227], a[104:107], v[64:67], 0
    v_max3_f32 v240, v240, v85, v86
    v_max_f32 v240, v240, v87
    v_mfma_f32_16x16x32_bf16 v[208:211], a[44:47], v[104:107], v[208:211]
    s_add_u32 m0, s59, 36864
    v_mov_b32 v241, v240
    v_mfma_f32_16x16x32_bf16 v[212:215], a[60:63], v[104:107], v[212:215]
    buffer_load_dwordx4 v20, s[12:15], s70 offen offset:0 nt lds
    v_mfma_f32_16x16x32_bf16 v[216:219], a[76:79], v[104:107], v[216:219]
    v_permlane32_swap_b32 v241, v240
    v_mfma_f32_16x16x32_bf16 v[220:223], a[92:95], v[104:107], v[220:223]
    s_add_u32 m0, s59, 36864
    v_max_f32 v240, v240, v241
    v_mov_b32 v241, v240
    v_mfma_f32_16x16x32_bf16 v[224:227], a[108:111], v[104:107], v[224:227]
    buffer_load_dwordx4 v21, s[12:15], s70 offen offset:1024 nt lds
    v_mfma_f32_16x16x32_bf16 v[208:211], a[48:51], v[144:147], v[208:211]
    v_permlane16_swap_b32 v241, v240
    v_mfma_f32_16x16x32_bf16 v[212:215], a[64:67], v[144:147], v[212:215]
    s_add_u32 m0, s59, 36864
    v_max_f32 v240, v240, v241
    v_mul_f32 v240, s66, v240
    v_mfma_f32_16x16x32_bf16 v[216:219], a[80:83], v[144:147], v[216:219]
    buffer_load_dwordx4 v20, s[12:15], s70 offen offset:2048 nt lds
    v_fma_f32 v52, v52, s66, -v240
    v_mfma_f32_16x16x32_bf16 v[220:223], a[96:99], v[144:147], v[220:223]
    v_fma_f32 v53, v53, s66, -v240
    v_fma_f32 v54, v54, s66, -v240
    v_mfma_f32_16x16x32_bf16 v[224:227], a[112:115], v[144:147], v[224:227]
    s_add_u32 m0, s59, 36864
    v_fma_f32 v55, v55, s66, -v240
    v_fma_f32 v60, v60, s66, -v240
    v_mfma_f32_16x16x32_bf16 v[208:211], a[52:55], v[184:187], v[208:211]
    s_add_u32 s60, s61, 0
    buffer_load_dwordx4 v21, s[12:15], s70 offen offset:3072 nt lds
    s_add_u32 m0, s59, 24576
    v_mfma_f32_16x16x32_bf16 v[212:215], a[68:71], v[184:187], v[212:215]
    buffer_load_dwordx4 v4, s[20:23], s60 offen lds
    v_fma_f32 v61, v61, s66, -v240
    v_mfma_f32_16x16x32_bf16 v[216:219], a[84:87], v[184:187], v[216:219]
    v_exp_f32 v52, v52
    v_mfma_f32_16x16x32_bf16 v[220:223], a[100:103], v[184:187], v[220:223]
    v_exp_f32 v53, v53
    v_mfma_f32_16x16x32_bf16 v[224:227], a[116:119], v[184:187], v[224:227]
    v_exp_f32 v54, v54
    v_exp_f32 v55, v55
    v_cvt_pk_bf16_f32 v56, v52, v53
    v_fma_f32 v62, v62, s66, -v240
    v_fma_f32 v63, v63, s66, -v240
    v_exp_f32 v60, v60
    v_exp_f32 v61, v61
    v_cvt_pk_bf16_f32 v57, v54, v55
    v_pk_fma_f32 v[68:69], v[68:69], s[66:67], v[240:241] op_sel_hi:[1,0,0] neg_lo:[0,0,1] neg_hi:[0,0,1]
    v_exp_f32 v62, v62
    v_exp_f32 v63, v63
    v_cvt_pk_bf16_f32 v58, v60, v61
    v_pk_fma_f32 v[70:71], v[70:71], s[66:67], v[240:241] op_sel_hi:[1,0,0] neg_lo:[0,0,1] neg_hi:[0,0,1]
    v_exp_f32 v68, v68
    v_exp_f32 v69, v69
    v_cvt_pk_bf16_f32 v59, v62, v63
    v_pk_fma_f32 v[76:77], v[76:77], s[66:67], v[240:241] op_sel_hi:[1,0,0] neg_lo:[0,0,1] neg_hi:[0,0,1]
    v_exp_f32 v70, v70
    v_exp_f32 v71, v71
    v_cvt_pk_bf16_f32 v96, v68, v69
    v_pk_fma_f32 v[78:79], v[78:79], s[66:67], v[240:241] op_sel_hi:[1,0,0] neg_lo:[0,0,1] neg_hi:[0,0,1]
    v_exp_f32 v76, v76
    v_exp_f32 v77, v77
    v_cvt_pk_bf16_f32 v97, v70, v71
    v_pk_fma_f32 v[84:85], v[84:85], s[66:67], v[240:241] op_sel_hi:[1,0,0] neg_lo:[0,0,1] neg_hi:[0,0,1]
    v_exp_f32 v78, v78
    v_exp_f32 v79, v79
    v_cvt_pk_bf16_f32 v98, v76, v77
    v_pk_fma_f32 v[86:87], v[86:87], s[66:67], v[240:241] op_sel_hi:[1,0,0] neg_lo:[0,0,1] neg_hi:[0,0,1]
    v_exp_f32 v84, v84
    v_exp_f32 v85, v85
    v_cvt_pk_bf16_f32 v99, v78, v79
    v_exp_f32 v86, v86
    v_exp_f32 v87, v87
    v_cvt_pk_bf16_f32 v136, v84, v85
    v_cvt_pk_bf16_f32 v137, v86, v87
    v_mfma_f32_16x16x32_bf16 v[52:55], a[40:43], v[72:75], 0
    v_max3_f32 v240, v208, v209, v210
    v_max3_f32 v240, v240, v211, v212
    v_mfma_f32_16x16x32_bf16 v[60:63], a[56:59], v[72:75], 0
    s_add_u32 m0, s59, 25600
    v_max3_f32 v240, v240, v213, v214
    v_max3_f32 v240, v240, v215, v216
    v_mfma_f32_16x16x32_bf16 v[68:71], a[72:75], v[72:75], 0
    buffer_load_dwordx4 v5, s[20:23], s60 offen lds
    v_max3_f32 v240, v240, v217, v218
    v_mfma_f32_16x16x32_bf16 v[76:79], a[88:91], v[72:75], 0
    v_max3_f32 v240, v240, v219, v220
    v_max3_f32 v240, v240, v221, v222
    v_mfma_f32_16x16x32_bf16 v[84:87], a[104:107], v[72:75], 0
    v_max3_f32 v240, v240, v223, v224
    v_max3_f32 v240, v240, v225, v226
    v_mfma_f32_16x16x32_bf16 v[52:55], a[44:47], v[112:115], v[52:55]
    v_max_f32 v240, v240, v227
    v_mov_b32 v241, v240
    v_mfma_f32_16x16x32_bf16 v[60:63], a[60:63], v[112:115], v[60:63]
    s_nop 0
    v_permlane32_swap_b32 v241, v240
    v_mfma_f32_16x16x32_bf16 v[68:71], a[76:79], v[112:115], v[68:71]
    s_add_u32 m0, s59, 26624
    v_max_f32 v240, v240, v241
    v_mov_b32 v241, v240
    v_mfma_f32_16x16x32_bf16 v[76:79], a[92:95], v[112:115], v[76:79]
    buffer_load_dwordx4 v6, s[20:23], s60 offen lds
    v_mfma_f32_16x16x32_bf16 v[84:87], a[108:111], v[112:115], v[84:87]
    v_permlane16_swap_b32 v241, v240
    v_mfma_f32_16x16x32_bf16 v[52:55], a[48:51], v[152:155], v[52:55]
    v_max_f32 v240, v240, v241
    v_mul_f32 v240, s66, v240
    v_mfma_f32_16x16x32_bf16 v[60:63], a[64:67], v[152:155], v[60:63]
    v_fma_f32 v208, v208, s66, -v240
    v_fma_f32 v209, v209, s66, -v240
    v_mfma_f32_16x16x32_bf16 v[68:71], a[80:83], v[152:155], v[68:71]
    v_fma_f32 v210, v210, s66, -v240
    v_fma_f32 v211, v211, s66, -v240
    v_mfma_f32_16x16x32_bf16 v[76:79], a[96:99], v[152:155], v[76:79]
    s_add_u32 m0, s59, 27648
    v_exp_f32 v208, v208
    v_mfma_f32_16x16x32_bf16 v[84:87], a[112:115], v[152:155], v[84:87]
    buffer_load_dwordx4 v7, s[20:23], s60 offen lds
    v_fma_f32 v212, v212, s66, -v240
    v_mfma_f32_16x16x32_bf16 v[52:55], a[52:55], v[192:195], v[52:55]
    v_exp_f32 v209, v209
    v_mfma_f32_16x16x32_bf16 v[60:63], a[68:71], v[192:195], v[60:63]
    v_fma_f32 v213, v213, s66, -v240
    v_cvt_pk_bf16_f32 v64, v208, v209
    v_mfma_f32_16x16x32_bf16 v[68:71], a[84:87], v[192:195], v[68:71]
    v_exp_f32 v210, v210
    v_mfma_f32_16x16x32_bf16 v[76:79], a[100:103], v[192:195], v[76:79]
    v_exp_f32 v211, v211
    v_mfma_f32_16x16x32_bf16 v[84:87], a[116:119], v[192:195], v[84:87]
    s_lshl_b32 s100, s54, 17
    s_lshl_b32 s101, s55, 13
    s_add_u32 s100, s100, s101
    v_fma_f32 v214, v214, s66, -v240
    v_fma_f32 v215, v215, s66, -v240
    v_exp_f32 v212, v212
    v_exp_f32 v213, v213
    v_cvt_pk_bf16_f32 v65, v210, v211
    v_pk_fma_f32 v[216:217], v[216:217], s[66:67], v[240:241] op_sel_hi:[1,0,0] neg_lo:[0,0,1] neg_hi:[0,0,1]
    v_exp_f32 v214, v214
    v_exp_f32 v215, v215
    v_cvt_pk_bf16_f32 v66, v212, v213
    v_pk_fma_f32 v[218:219], v[218:219], s[66:67], v[240:241] op_sel_hi:[1,0,0] neg_lo:[0,0,1] neg_hi:[0,0,1]
    v_exp_f32 v216, v216
    v_exp_f32 v217, v217
    v_cvt_pk_bf16_f32 v67, v214, v215
    v_pk_fma_f32 v[220:221], v[220:221], s[66:67], v[240:241] op_sel_hi:[1,0,0] neg_lo:[0,0,1] neg_hi:[0,0,1]
    v_exp_f32 v218, v218
    v_exp_f32 v219, v219
    v_cvt_pk_bf16_f32 v104, v216, v217
    v_pk_fma_f32 v[222:223], v[222:223], s[66:67], v[240:241] op_sel_hi:[1,0,0] neg_lo:[0,0,1] neg_hi:[0,0,1]
    v_exp_f32 v220, v220
    v_exp_f32 v221, v221
    v_cvt_pk_bf16_f32 v105, v218, v219
    v_pk_fma_f32 v[224:225], v[224:225], s[66:67], v[240:241] op_sel_hi:[1,0,0] neg_lo:[0,0,1] neg_hi:[0,0,1]
    v_exp_f32 v222, v222
    v_exp_f32 v223, v223
    v_cvt_pk_bf16_f32 v106, v220, v221
    v_pk_fma_f32 v[226:227], v[226:227], s[66:67], v[240:241] op_sel_hi:[1,0,0] neg_lo:[0,0,1] neg_hi:[0,0,1]
    v_exp_f32 v224, v224
    v_exp_f32 v225, v225
    v_cvt_pk_bf16_f32 v107, v222, v223
    v_exp_f32 v226, v226
    v_exp_f32 v227, v227
    v_cvt_pk_bf16_f32 v144, v224, v225
    v_cvt_pk_bf16_f32 v145, v226, v227
    v_mfma_f32_16x16x32_bf16 v[208:211], a[40:43], v[80:83], 0
    buffer_load_dword v255, v254, s[20:23], s100 offen
    v_max3_f32 v240, v52, v53, v54
    v_mfma_f32_16x16x32_bf16 v[212:215], a[56:59], v[80:83], 0
    v_max3_f32 v240, v240, v55, v60
    v_max3_f32 v240, v240, v61, v62
    v_mfma_f32_16x16x32_bf16 v[216:219], a[72:75], v[80:83], 0
    v_max3_f32 v240, v240, v63, v68
    v_max3_f32 v240, v240, v69, v70
    v_mfma_f32_16x16x32_bf16 v[220:223], a[88:91], v[80:83], 0
    v_max3_f32 v240, v240, v71, v76
    v_max3_f32 v240, v240, v77, v78
    v_mfma_f32_16x16x32_bf16 v[224:227], a[104:107], v[80:83], 0
    v_max3_f32 v240, v240, v79, v84
    v_max3_f32 v240, v240, v85, v86
    v_mfma_f32_16x16x32_bf16 v[208:211], a[44:47], v[120:123], v[208:211]
    v_max_f32 v240, v240, v87
    v_mov_b32 v241, v240
    v_mfma_f32_16x16x32_bf16 v[212:215], a[60:63], v[120:123], v[212:215]
    s_nop 0
    v_permlane32_swap_b32 v241, v240
    v_mfma_f32_16x16x32_bf16 v[216:219], a[76:79], v[120:123], v[216:219]
    v_max_f32 v240, v240, v241
    v_mov_b32 v241, v240
    v_mfma_f32_16x16x32_bf16 v[220:223], a[92:95], v[120:123], v[220:223]
    s_nop 0
    v_permlane16_swap_b32 v241, v240
    v_mfma_f32_16x16x32_bf16 v[224:227], a[108:111], v[120:123], v[224:227]
    s_waitcnt vmcnt(14)
    v_max_f32 v240, v240, v241
    v_mul_f32 v240, s66, v240
    v_mfma_f32_16x16x32_bf16 v[208:211], a[48:51], v[160:163], v[208:211]
    ds_read_b64_tr_b16 a[124:125], v22 offset:28672
    v_fma_f32 v52, v52, s66, -v240
    v_mfma_f32_16x16x32_bf16 v[212:215], a[64:67], v[160:163], v[212:215]
    ds_read_b64_tr_b16 a[134:135], v23 offset:28672
    v_fma_f32 v53, v53, s66, -v240
    v_mfma_f32_16x16x32_bf16 v[216:219], a[80:83], v[160:163], v[216:219]
    ds_read_b64_tr_b16 a[144:145], v24 offset:28672
    v_fma_f32 v54, v54, s66, -v240
    v_mfma_f32_16x16x32_bf16 v[220:223], a[96:99], v[160:163], v[220:223]
    ds_read_b64_tr_b16 a[154:155], v19 offset:28672
    v_fma_f32 v55, v55, s66, -v240
    v_mfma_f32_16x16x32_bf16 v[224:227], a[112:115], v[160:163], v[224:227]
    ds_read_b64_tr_b16 a[164:165], v228 offset:28672
    v_fma_f32 v60, v60, s66, -v240
    v_mfma_f32_16x16x32_bf16 v[208:211], a[52:55], v[200:203], v[208:211]
    ds_read_b64_tr_b16 a[174:175], v229 offset:28672
    v_fma_f32 v61, v61, s66, -v240
    v_mfma_f32_16x16x32_bf16 v[212:215], a[68:71], v[200:203], v[212:215]
    ds_read_b64_tr_b16 a[184:185], v230 offset:28672
    v_fma_f32 v62, v62, s66, -v240
    v_mfma_f32_16x16x32_bf16 v[216:219], a[84:87], v[200:203], v[216:219]
    ds_read_b64_tr_b16 a[194:195], v231 offset:28672
    v_fma_f32 v63, v63, s66, -v240
    v_mfma_f32_16x16x32_bf16 v[220:223], a[100:103], v[200:203], v[220:223]
    v_exp_f32 v52, v52
    v_exp_f32 v53, v53
    v_exp_f32 v54, v54
    v_exp_f32 v55, v55
    v_cvt_pk_bf16_f32 v72, v52, v53
    v_exp_f32 v60, v60
    v_exp_f32 v61, v61
    v_cvt_pk_bf16_f32 v73, v54, v55
    v_pk_fma_f32 v[68:69], v[68:69], s[66:67], v[240:241] op_sel_hi:[1,0,0] neg_lo:[0,0,1] neg_hi:[0,0,1]
    v_exp_f32 v62, v62
    v_exp_f32 v63, v63
    v_cvt_pk_bf16_f32 v74, v60, v61
    v_pk_fma_f32 v[70:71], v[70:71], s[66:67], v[240:241] op_sel_hi:[1,0,0] neg_lo:[0,0,1] neg_hi:[0,0,1]
    v_exp_f32 v68, v68
    v_exp_f32 v69, v69
    v_cvt_pk_bf16_f32 v75, v62, v63
    v_pk_fma_f32 v[76:77], v[76:77], s[66:67], v[240:241] op_sel_hi:[1,0,0] neg_lo:[0,0,1] neg_hi:[0,0,1]
    v_exp_f32 v70, v70
    v_exp_f32 v71, v71
    v_cvt_pk_bf16_f32 v112, v68, v69
    v_pk_fma_f32 v[78:79], v[78:79], s[66:67], v[240:241] op_sel_hi:[1,0,0] neg_lo:[0,0,1] neg_hi:[0,0,1]
    v_exp_f32 v76, v76
    v_exp_f32 v77, v77
    v_cvt_pk_bf16_f32 v113, v70, v71
    v_pk_fma_f32 v[84:85], v[84:85], s[66:67], v[240:241] op_sel_hi:[1,0,0] neg_lo:[0,0,1] neg_hi:[0,0,1]
    v_exp_f32 v78, v78
    v_exp_f32 v79, v79
    v_cvt_pk_bf16_f32 v114, v76, v77
    v_pk_fma_f32 v[86:87], v[86:87], s[66:67], v[240:241] op_sel_hi:[1,0,0] neg_lo:[0,0,1] neg_hi:[0,0,1]
    v_exp_f32 v84, v84
    v_exp_f32 v85, v85
    v_cvt_pk_bf16_f32 v115, v78, v79
    v_exp_f32 v86, v86
    v_exp_f32 v87, v87
    v_cvt_pk_bf16_f32 v152, v84, v85
    v_cvt_pk_bf16_f32 v153, v86, v87
    v_mfma_f32_16x16x32_bf16 v[224:227], a[116:119], v[200:203], v[224:227]
    s_waitcnt vmcnt(9)
    v_max3_f32 v240, v208, v209, v210
    v_max3_f32 v240, v240, v211, v212
    v_max3_f32 v240, v240, v213, v214
    v_max3_f32 v240, v240, v215, v216
    v_max3_f32 v240, v240, v217, v218
    v_max3_f32 v240, v240, v219, v220
    v_max3_f32 v240, v240, v221, v222
    v_max3_f32 v240, v240, v223, v224
    v_max3_f32 v240, v240, v225, v226
    v_max_f32 v240, v240, v227
    v_mov_b32 v241, v240
    s_nop 1
    v_permlane32_swap_b32 v241, v240
    v_max_f32 v240, v240, v241
    v_mov_b32 v241, v240
    s_nop 1
    v_permlane16_swap_b32 v241, v240
    v_max_f32 v240, v240, v241
    v_mul_f32 v240, s66, v240
    v_pk_fma_f32 v[208:209], v[208:209], s[66:67], v[240:241] op_sel_hi:[1,0,0] neg_lo:[0,0,1] neg_hi:[0,0,1]
    v_pk_fma_f32 v[210:211], v[210:211], s[66:67], v[240:241] op_sel_hi:[1,0,0] neg_lo:[0,0,1] neg_hi:[0,0,1]
    v_exp_f32 v208, v208
    v_exp_f32 v209, v209
    v_pk_fma_f32 v[212:213], v[212:213], s[66:67], v[240:241] op_sel_hi:[1,0,0] neg_lo:[0,0,1] neg_hi:[0,0,1]
    v_exp_f32 v210, v210
    v_exp_f32 v211, v211
    v_cvt_pk_bf16_f32 v80, v208, v209
    v_pk_fma_f32 v[214:215], v[214:215], s[66:67], v[240:241] op_sel_hi:[1,0,0] neg_lo:[0,0,1] neg_hi:[0,0,1]
    v_exp_f32 v212, v212
    v_exp_f32 v213, v213
    v_cvt_pk_bf16_f32 v81, v210, v211
    v_pk_fma_f32 v[216:217], v[216:217], s[66:67], v[240:241] op_sel_hi:[1,0,0] neg_lo:[0,0,1] neg_hi:[0,0,1]
    v_exp_f32 v214, v214
    v_exp_f32 v215, v215
    v_cvt_pk_bf16_f32 v82, v212, v213
    v_pk_fma_f32 v[218:219], v[218:219], s[66:67], v[240:241] op_sel_hi:[1,0,0] neg_lo:[0,0,1] neg_hi:[0,0,1]
    v_exp_f32 v216, v216
    v_exp_f32 v217, v217
    v_cvt_pk_bf16_f32 v83, v214, v215
    v_pk_fma_f32 v[220:221], v[220:221], s[66:67], v[240:241] op_sel_hi:[1,0,0] neg_lo:[0,0,1] neg_hi:[0,0,1]
    v_exp_f32 v218, v218
    v_exp_f32 v219, v219
    v_cvt_pk_bf16_f32 v120, v216, v217
    v_pk_fma_f32 v[222:223], v[222:223], s[66:67], v[240:241] op_sel_hi:[1,0,0] neg_lo:[0,0,1] neg_hi:[0,0,1]
    v_exp_f32 v220, v220
    v_exp_f32 v221, v221
    v_cvt_pk_bf16_f32 v121, v218, v219
    v_pk_fma_f32 v[224:225], v[224:225], s[66:67], v[240:241] op_sel_hi:[1,0,0] neg_lo:[0,0,1] neg_hi:[0,0,1]
    v_exp_f32 v222, v222
    v_exp_f32 v223, v223
    v_cvt_pk_bf16_f32 v122, v220, v221
    v_pk_fma_f32 v[226:227], v[226:227], s[66:67], v[240:241] op_sel_hi:[1,0,0] neg_lo:[0,0,1] neg_hi:[0,0,1]
    v_exp_f32 v224, v224
    v_exp_f32 v225, v225
    v_cvt_pk_bf16_f32 v123, v222, v223
    v_exp_f32 v226, v226
    v_exp_f32 v227, v227
    v_cvt_pk_bf16_f32 v160, v224, v225
    v_cvt_pk_bf16_f32 v161, v226, v227
    v_mfma_f32_16x16x32_bf16 v[156:159], v[232:235], v[48:51], 0
    ds_read_b64_tr_b16 a[136:137], v23 offset:32768
    ds_read_b64_tr_b16 a[126:127], v22 offset:32768
    v_mfma_f32_16x16x32_bf16 v[92:95], a[120:123], v[48:51], 0
    ds_read_b64_tr_b16 a[156:157], v19 offset:32768
    ds_read_b64_tr_b16 a[146:147], v24 offset:32768
    v_mfma_f32_16x16x32_bf16 v[100:103], a[130:133], v[48:51], 0
    ds_read_b64_tr_b16 a[166:167], v228 offset:32768
    v_mfma_f32_16x16x32_bf16 v[108:111], a[140:143], v[48:51], 0
    ds_read_b64_tr_b16 a[176:177], v229 offset:32768
    v_mfma_f32_16x16x32_bf16 v[116:119], a[150:153], v[48:51], 0
    ds_read_b64_tr_b16 a[186:187], v230 offset:32768
    v_mfma_f32_16x16x32_bf16 v[124:127], a[160:163], v[48:51], 0
    ds_read_b64_tr_b16 a[196:197], v231 offset:32768
    v_mfma_f32_16x16x32_bf16 v[132:135], a[170:173], v[48:51], 0
    v_mfma_f32_16x16x32_bf16 v[140:143], a[180:183], v[48:51], 0
    s_waitcnt vmcnt(5)
    v_mfma_f32_16x16x32_bf16 v[148:151], a[190:193], v[48:51], 0
    s_waitcnt lgkmcnt(8)
    ds_read_b64_tr_b16 a[128:129], v22 offset:36864
    s_waitcnt lgkmcnt(1)
    v_mfma_f32_16x16x32_bf16 v[156:159], v[232:235], v[88:91], v[156:159]
    ds_read_b64_tr_b16 a[138:139], v23 offset:36864
    v_mfma_f32_16x16x32_bf16 v[92:95], a[124:127], v[88:91], v[92:95]
    ds_read_b64_tr_b16 a[148:149], v24 offset:36864
    v_mfma_f32_16x16x32_bf16 v[100:103], a[134:137], v[88:91], v[100:103]
    ds_read_b64_tr_b16 a[158:159], v19 offset:36864
    v_mfma_f32_16x16x32_bf16 v[108:111], a[144:147], v[88:91], v[108:111]
    ds_read_b64_tr_b16 a[168:169], v228 offset:36864
    v_mfma_f32_16x16x32_bf16 v[116:119], a[154:157], v[88:91], v[116:119]
    ds_read_b64_tr_b16 a[178:179], v229 offset:36864
    v_mfma_f32_16x16x32_bf16 v[124:127], a[164:167], v[88:91], v[124:127]
    ds_read_b64_tr_b16 a[188:189], v230 offset:36864
    v_mfma_f32_16x16x32_bf16 v[132:135], a[174:177], v[88:91], v[132:135]
    ds_read_b64_tr_b16 a[198:199], v231 offset:36864
    v_mfma_f32_16x16x32_bf16 v[140:143], a[184:187], v[88:91], v[140:143]
    v_mfma_f32_16x16x32_bf16 v[148:151], a[194:197], v[88:91], v[148:151]
    s_waitcnt lgkmcnt(0)
    v_mfma_f32_16x16x16_bf16 v[156:159], v[232:233], v[128:129], v[156:159]
    v_mfma_f32_16x16x16_bf16 v[92:95], a[128:129], v[128:129], v[92:95]
    v_mfma_f32_16x16x16_bf16 v[100:103], a[138:139], v[128:129], v[100:103]
    v_mfma_f32_16x16x16_bf16 v[108:111], a[148:149], v[128:129], v[108:111]
    s_nop 4
    v_rcp_f32 v242, v156
    v_mfma_f32_16x16x16_bf16 v[116:119], a[158:159], v[128:129], v[116:119]
    v_mul_f32 v92, v92, v242
    v_mul_f32 v93, v93, v242
    v_mfma_f32_16x16x16_bf16 v[124:127], a[168:169], v[128:129], v[124:127]
    v_mul_f32 v94, v94, v242
    v_mul_f32 v95, v95, v242
    v_mfma_f32_16x16x16_bf16 v[132:135], a[178:179], v[128:129], v[132:135]
    v_mul_f32 v100, v100, v242
    v_mul_f32 v101, v101, v242
    v_mfma_f32_16x16x16_bf16 v[140:143], a[188:189], v[128:129], v[140:143]
    v_mul_f32 v102, v102, v242
    v_mul_f32 v103, v103, v242
    v_mfma_f32_16x16x16_bf16 v[148:151], a[198:199], v[128:129], v[148:151]
    v_cvt_pk_bf16_f32 v48, v92, v93
    v_cvt_pk_bf16_f32 v49, v94, v95
    v_mfma_f32_16x16x32_bf16 v[188:191], v[232:235], v[56:59], 0
    v_cvt_pk_bf16_f32 v50, v100, v101
    v_cvt_pk_bf16_f32 v51, v102, v103
    v_mfma_f32_16x16x32_bf16 v[52:55], a[120:123], v[56:59], 0
    ds_write_b128 v25, v[48:51] offset:0
    v_mfma_f32_16x16x32_bf16 v[60:63], a[130:133], v[56:59], 0
    v_mul_f32 v108, v108, v242
    v_mul_f32 v109, v109, v242
    v_mfma_f32_16x16x32_bf16 v[68:71], a[140:143], v[56:59], 0
    v_cvt_pk_bf16_f32 v88, v108, v109
    v_mul_f32 v110, v110, v242
    v_mfma_f32_16x16x32_bf16 v[76:79], a[150:153], v[56:59], 0
    v_mul_f32 v111, v111, v242
    v_cvt_pk_bf16_f32 v89, v110, v111
    v_mfma_f32_16x16x32_bf16 v[84:87], a[160:163], v[56:59], 0
    v_mul_f32 v116, v116, v242
    v_mul_f32 v117, v117, v242
    v_mfma_f32_16x16x32_bf16 v[164:167], a[170:173], v[56:59], 0
    v_cvt_pk_bf16_f32 v90, v116, v117
    v_mul_f32 v118, v118, v242
    v_mfma_f32_16x16x32_bf16 v[172:175], a[180:183], v[56:59], 0
    v_mul_f32 v119, v119, v242
    v_cvt_pk_bf16_f32 v91, v118, v119
    v_mfma_f32_16x16x32_bf16 v[180:183], a[190:193], v[56:59], 0
    s_add_u32 s60, s61, 32768
    s_add_u32 m0, s59, 20480
    v_mul_f32 v124, v124, v242
    v_mfma_f32_16x16x32_bf16 v[188:191], v[232:235], v[96:99], v[188:191]
    buffer_load_dwordx4 v4, s[20:23], s60 offen lds
    v_mul_f32 v125, v125, v242
    v_mfma_f32_16x16x32_bf16 v[52:55], a[124:127], v[96:99], v[52:55]
    ds_write_b128 v25, v[88:91] offset:5120
    v_mfma_f32_16x16x32_bf16 v[60:63], a[134:137], v[96:99], v[60:63]
    v_cvt_pk_bf16_f32 v128, v124, v125
    v_mul_f32 v126, v126, v242
    v_mfma_f32_16x16x32_bf16 v[68:71], a[144:147], v[96:99], v[68:71]
    v_mul_f32 v127, v127, v242
    v_cvt_pk_bf16_f32 v129, v126, v127
    v_mfma_f32_16x16x32_bf16 v[76:79], a[154:157], v[96:99], v[76:79]
    v_mul_f32 v132, v132, v242
    v_mul_f32 v133, v133, v242
    v_mfma_f32_16x16x32_bf16 v[84:87], a[164:167], v[96:99], v[84:87]
    v_cvt_pk_bf16_f32 v130, v132, v133
    v_mul_f32 v134, v134, v242
    v_mfma_f32_16x16x32_bf16 v[164:167], a[174:177], v[96:99], v[164:167]
    s_add_u32 m0, s59, 21504
    v_mul_f32 v135, v135, v242
    v_cvt_pk_bf16_f32 v131, v134, v135
    v_mfma_f32_16x16x32_bf16 v[172:175], a[184:187], v[96:99], v[172:175]
    buffer_load_dwordx4 v5, s[20:23], s60 offen lds
    v_mul_f32 v140, v140, v242
    v_mfma_f32_16x16x32_bf16 v[180:183], a[194:197], v[96:99], v[180:183]
    ds_write_b128 v25, v[128:131] offset:10240
    v_mfma_f32_16x16x16_bf16 v[188:191], v[232:233], v[136:137], v[188:191]
    v_mul_f32 v141, v141, v242
    v_cvt_pk_bf16_f32 v168, v140, v141
    v_mfma_f32_16x16x16_bf16 v[52:55], a[128:129], v[136:137], v[52:55]
    v_mul_f32 v142, v142, v242
    v_mul_f32 v143, v143, v242
    v_mfma_f32_16x16x16_bf16 v[60:63], a[138:139], v[136:137], v[60:63]
    v_cvt_pk_bf16_f32 v169, v142, v143
    v_mul_f32 v148, v148, v242
    v_mfma_f32_16x16x16_bf16 v[68:71], a[148:149], v[136:137], v[68:71]
    v_mul_f32 v149, v149, v242
    v_cvt_pk_bf16_f32 v170, v148, v149
    v_mfma_f32_16x16x16_bf16 v[76:79], a[158:159], v[136:137], v[76:79]
    s_add_u32 m0, s59, 22528
    v_mul_f32 v150, v150, v242
    v_mul_f32 v151, v151, v242
    v_mfma_f32_16x16x16_bf16 v[84:87], a[168:169], v[136:137], v[84:87]
    buffer_load_dwordx4 v6, s[20:23], s60 offen lds
    v_cvt_pk_bf16_f32 v171, v150, v151
    v_mfma_f32_16x16x16_bf16 v[164:167], a[178:179], v[136:137], v[164:167]
    ds_write_b128 v25, v[168:171] offset:15360
    v_mfma_f32_16x16x16_bf16 v[172:175], a[188:189], v[136:137], v[172:175]
    v_rcp_f32 v242, v188
    v_mfma_f32_16x16x16_bf16 v[180:183], a[198:199], v[136:137], v[180:183]
    v_mul_f32 v52, v52, v242
    v_mul_f32 v53, v53, v242
    v_mfma_f32_16x16x32_bf16 v[156:159], v[232:235], v[64:67], 0
    v_cvt_pk_bf16_f32 v56, v52, v53
    v_mul_f32 v54, v54, v242
    v_mfma_f32_16x16x32_bf16 v[92:95], a[120:123], v[64:67], 0
    v_mul_f32 v55, v55, v242
    v_cvt_pk_bf16_f32 v57, v54, v55
    v_mfma_f32_16x16x32_bf16 v[100:103], a[130:133], v[64:67], 0
    s_add_u32 m0, s59, 23552
    v_mul_f32 v60, v60, v242
    v_mul_f32 v61, v61, v242
    v_mfma_f32_16x16x32_bf16 v[108:111], a[140:143], v[64:67], 0
    buffer_load_dwordx4 v7, s[20:23], s60 offen lds
    v_cvt_pk_bf16_f32 v58, v60, v61
    v_mfma_f32_16x16x32_bf16 v[116:119], a[150:153], v[64:67], 0
    v_mul_f32 v62, v62, v242
    v_mul_f32 v63, v63, v242
    v_mfma_f32_16x16x32_bf16 v[124:127], a[160:163], v[64:67], 0
    v_cvt_pk_bf16_f32 v59, v62, v63
    v_mul_f32 v68, v68, v242
    v_mfma_f32_16x16x32_bf16 v[132:135], a[170:173], v[64:67], 0
    ds_write_b128 v25, v[56:59] offset:1024
    v_mfma_f32_16x16x32_bf16 v[140:143], a[180:183], v[64:67], 0
    v_mul_f32 v69, v69, v242
    v_cvt_pk_bf16_f32 v96, v68, v69
    v_mfma_f32_16x16x32_bf16 v[148:151], a[190:193], v[64:67], 0
    v_mul_f32 v70, v70, v242
    v_mul_f32 v71, v71, v242
    v_mfma_f32_16x16x32_bf16 v[156:159], v[232:235], v[104:107], v[156:159]
    s_add_u32 s60, s61, 65536
    s_add_u32 m0, s59, 28672
    v_cvt_pk_bf16_f32 v97, v70, v71
    v_mfma_f32_16x16x32_bf16 v[92:95], a[124:127], v[104:107], v[92:95]
    buffer_load_dwordx4 v4, s[20:23], s60 offen lds
    v_mul_f32 v76, v76, v242
    v_mfma_f32_16x16x32_bf16 v[100:103], a[134:137], v[104:107], v[100:103]
    v_mul_f32 v77, v77, v242
    v_cvt_pk_bf16_f32 v98, v76, v77
    v_mfma_f32_16x16x32_bf16 v[108:111], a[144:147], v[104:107], v[108:111]
    v_mul_f32 v78, v78, v242
    v_mul_f32 v79, v79, v242
    v_mfma_f32_16x16x32_bf16 v[116:119], a[154:157], v[104:107], v[116:119]
    v_cvt_pk_bf16_f32 v99, v78, v79
    v_mul_f32 v84, v84, v242
    v_mfma_f32_16x16x32_bf16 v[124:127], a[164:167], v[104:107], v[124:127]
    ds_write_b128 v25, v[96:99] offset:6144
    v_mfma_f32_16x16x32_bf16 v[132:135], a[174:177], v[104:107], v[132:135]
    v_mul_f32 v85, v85, v242
    v_cvt_pk_bf16_f32 v136, v84, v85
    v_mfma_f32_16x16x32_bf16 v[140:143], a[184:187], v[104:107], v[140:143]
    s_add_u32 m0, s59, 29696
    v_mul_f32 v86, v86, v242
    v_mul_f32 v87, v87, v242
    v_mfma_f32_16x16x32_bf16 v[148:151], a[194:197], v[104:107], v[148:151]
    buffer_load_dwordx4 v5, s[20:23], s60 offen lds
    v_cvt_pk_bf16_f32 v137, v86, v87
    v_mfma_f32_16x16x16_bf16 v[156:159], v[232:233], v[144:145], v[156:159]
    v_mul_f32 v164, v164, v242
    v_mul_f32 v165, v165, v242
    v_mfma_f32_16x16x16_bf16 v[92:95], a[128:129], v[144:145], v[92:95]
    v_cvt_pk_bf16_f32 v138, v164, v165
    v_mul_f32 v166, v166, v242
    v_mfma_f32_16x16x16_bf16 v[100:103], a[138:139], v[144:145], v[100:103]
    v_mul_f32 v167, v167, v242
    v_cvt_pk_bf16_f32 v139, v166, v167
    v_mfma_f32_16x16x16_bf16 v[108:111], a[148:149], v[144:145], v[108:111]
    ds_write_b128 v25, v[136:139] offset:11264
    v_mfma_f32_16x16x16_bf16 v[116:119], a[158:159], v[144:145], v[116:119]
    v_mul_f32 v172, v172, v242
    v_mul_f32 v173, v173, v242
    v_mfma_f32_16x16x16_bf16 v[124:127], a[168:169], v[144:145], v[124:127]
    s_add_u32 m0, s59, 30720
    v_cvt_pk_bf16_f32 v176, v172, v173
    v_mul_f32 v174, v174, v242
    v_mfma_f32_16x16x16_bf16 v[132:135], a[178:179], v[144:145], v[132:135]
    buffer_load_dwordx4 v6, s[20:23], s60 offen lds
    v_mul_f32 v175, v175, v242
    v_mfma_f32_16x16x16_bf16 v[140:143], a[188:189], v[144:145], v[140:143]
    v_cvt_pk_bf16_f32 v177, v174, v175
    v_mul_f32 v180, v180, v242
    v_mfma_f32_16x16x16_bf16 v[148:151], a[198:199], v[144:145], v[148:151]
    v_mul_f32 v181, v181, v242
    v_cvt_pk_bf16_f32 v178, v180, v181
    v_mul_f32 v182, v182, v242
    v_mul_f32 v183, v183, v242
    v_cvt_pk_bf16_f32 v179, v182, v183
    ds_write_b128 v25, v[176:179] offset:16384
    v_mfma_f32_16x16x32_bf16 v[188:191], v[232:235], v[72:75], 0
    v_rcp_f32 v242, v156
    v_mfma_f32_16x16x32_bf16 v[52:55], a[120:123], v[72:75], 0
    v_mul_f32 v92, v92, v242
    v_mul_f32 v93, v93, v242
    v_mfma_f32_16x16x32_bf16 v[60:63], a[130:133], v[72:75], 0
    v_cvt_pk_bf16_f32 v64, v92, v93
    v_mul_f32 v94, v94, v242
    v_mfma_f32_16x16x32_bf16 v[68:71], a[140:143], v[72:75], 0
    s_add_u32 m0, s59, 31744
    v_mul_f32 v95, v95, v242
    v_cvt_pk_bf16_f32 v65, v94, v95
    v_mfma_f32_16x16x32_bf16 v[76:79], a[150:153], v[72:75], 0
    buffer_load_dwordx4 v7, s[20:23], s60 offen lds
    v_mul_f32 v100, v100, v242
    v_mfma_f32_16x16x32_bf16 v[84:87], a[160:163], v[72:75], 0
    v_mul_f32 v101, v101, v242
    v_cvt_pk_bf16_f32 v66, v100, v101
    v_mfma_f32_16x16x32_bf16 v[164:167], a[170:173], v[72:75], 0
    v_mul_f32 v102, v102, v242
    v_mul_f32 v103, v103, v242
    v_mfma_f32_16x16x32_bf16 v[172:175], a[180:183], v[72:75], 0
    v_cvt_pk_bf16_f32 v67, v102, v103
    v_mul_f32 v108, v108, v242
    v_mfma_f32_16x16x32_bf16 v[180:183], a[190:193], v[72:75], 0
    ds_write_b128 v25, v[64:67] offset:2048
    v_mfma_f32_16x16x32_bf16 v[188:191], v[232:235], v[112:115], v[188:191]
    v_mul_f32 v109, v109, v242
    v_cvt_pk_bf16_f32 v104, v108, v109
    v_mfma_f32_16x16x32_bf16 v[52:55], a[124:127], v[112:115], v[52:55]
    s_add_u32 s60, s61, 98304
    s_add_u32 m0, s59, 32768
    v_mul_f32 v110, v110, v242
    v_mfma_f32_16x16x32_bf16 v[60:63], a[134:137], v[112:115], v[60:63]
    buffer_load_dwordx4 v4, s[20:23], s60 offen lds
    v_mul_f32 v111, v111, v242
    v_mfma_f32_16x16x32_bf16 v[68:71], a[144:147], v[112:115], v[68:71]
    v_cvt_pk_bf16_f32 v105, v110, v111
    v_mul_f32 v116, v116, v242
    v_mfma_f32_16x16x32_bf16 v[76:79], a[154:157], v[112:115], v[76:79]
    v_mul_f32 v117, v117, v242
    v_cvt_pk_bf16_f32 v106, v116, v117
    v_mfma_f32_16x16x32_bf16 v[84:87], a[164:167], v[112:115], v[84:87]
    v_mul_f32 v118, v118, v242
    v_mul_f32 v119, v119, v242
    v_mfma_f32_16x16x32_bf16 v[164:167], a[174:177], v[112:115], v[164:167]
    v_cvt_pk_bf16_f32 v107, v118, v119
    v_mul_f32 v124, v124, v242
    v_mfma_f32_16x16x32_bf16 v[172:175], a[184:187], v[112:115], v[172:175]
    ds_write_b128 v25, v[104:107] offset:7168
    v_mfma_f32_16x16x32_bf16 v[180:183], a[194:197], v[112:115], v[180:183]
    s_add_u32 m0, s59, 33792
    v_mul_f32 v125, v125, v242
    v_cvt_pk_bf16_f32 v144, v124, v125
    v_mfma_f32_16x16x16_bf16 v[188:191], v[232:233], v[152:153], v[188:191]
    buffer_load_dwordx4 v5, s[20:23], s60 offen lds
    v_mul_f32 v126, v126, v242
    v_mfma_f32_16x16x16_bf16 v[52:55], a[128:129], v[152:153], v[52:55]
    v_mul_f32 v127, v127, v242
    v_cvt_pk_bf16_f32 v145, v126, v127
    v_mfma_f32_16x16x16_bf16 v[60:63], a[138:139], v[152:153], v[60:63]
    v_mul_f32 v132, v132, v242
    v_mul_f32 v133, v133, v242
    v_mfma_f32_16x16x16_bf16 v[68:71], a[148:149], v[152:153], v[68:71]
    v_cvt_pk_bf16_f32 v146, v132, v133
    v_mul_f32 v134, v134, v242
    v_mfma_f32_16x16x16_bf16 v[76:79], a[158:159], v[152:153], v[76:79]
    v_mul_f32 v135, v135, v242
    v_cvt_pk_bf16_f32 v147, v134, v135
    v_mfma_f32_16x16x16_bf16 v[84:87], a[168:169], v[152:153], v[84:87]
    ds_write_b128 v25, v[144:147] offset:12288
    v_mfma_f32_16x16x16_bf16 v[164:167], a[178:179], v[152:153], v[164:167]
    s_add_u32 m0, s59, 34816
    v_mul_f32 v140, v140, v242
    v_mul_f32 v141, v141, v242
    v_mfma_f32_16x16x16_bf16 v[172:175], a[188:189], v[152:153], v[172:175]
    buffer_load_dwordx4 v6, s[20:23], s60 offen lds
    v_cvt_pk_bf16_f32 v184, v140, v141
    v_mfma_f32_16x16x16_bf16 v[180:183], a[198:199], v[152:153], v[180:183]
    v_mul_f32 v142, v142, v242
    v_mul_f32 v143, v143, v242
    v_cvt_pk_bf16_f32 v185, v142, v143
    v_mul_f32 v148, v148, v242
    v_mul_f32 v149, v149, v242
    v_cvt_pk_bf16_f32 v186, v148, v149
    v_mul_f32 v150, v150, v242
    v_mul_f32 v151, v151, v242
    v_cvt_pk_bf16_f32 v187, v150, v151
    ds_write_b128 v25, v[184:187] offset:17408
    v_mfma_f32_16x16x32_bf16 v[156:159], v[232:235], v[80:83], 0
    v_rcp_f32 v242, v188
    v_mfma_f32_16x16x32_bf16 v[92:95], a[120:123], v[80:83], 0
    v_mul_f32 v52, v52, v242
    v_mul_f32 v53, v53, v242
    v_mfma_f32_16x16x32_bf16 v[100:103], a[130:133], v[80:83], 0
    v_cvt_pk_bf16_f32 v72, v52, v53
    v_mul_f32 v54, v54, v242
    v_mfma_f32_16x16x32_bf16 v[108:111], a[140:143], v[80:83], 0
    v_mul_f32 v55, v55, v242
    v_cvt_pk_bf16_f32 v73, v54, v55
    v_mfma_f32_16x16x32_bf16 v[116:119], a[150:153], v[80:83], 0
    s_add_u32 m0, s59, 35840
    v_mul_f32 v60, v60, v242
    v_mul_f32 v61, v61, v242
    v_mfma_f32_16x16x32_bf16 v[124:127], a[160:163], v[80:83], 0
    buffer_load_dwordx4 v7, s[20:23], s60 offen lds
    v_cvt_pk_bf16_f32 v74, v60, v61
    v_mfma_f32_16x16x32_bf16 v[132:135], a[170:173], v[80:83], 0
    v_mul_f32 v62, v62, v242
    v_mul_f32 v63, v63, v242
    v_mfma_f32_16x16x32_bf16 v[140:143], a[180:183], v[80:83], 0
    v_cvt_pk_bf16_f32 v75, v62, v63
    v_mul_f32 v68, v68, v242
    v_mfma_f32_16x16x32_bf16 v[148:151], a[190:193], v[80:83], 0
    ds_write_b128 v25, v[72:75] offset:3072
    v_mfma_f32_16x16x32_bf16 v[156:159], v[232:235], v[120:123], v[156:159]
    v_mul_f32 v69, v69, v242
    v_cvt_pk_bf16_f32 v112, v68, v69
    v_mfma_f32_16x16x32_bf16 v[92:95], a[124:127], v[120:123], v[92:95]
    v_mul_f32 v70, v70, v242
    v_mul_f32 v71, v71, v242
    v_mfma_f32_16x16x32_bf16 v[100:103], a[134:137], v[120:123], v[100:103]
    s_add_u32 s60, s62, 0
    s_add_u32 m0, s59, 36864
    v_cvt_pk_bf16_f32 v113, v70, v71
    v_mfma_f32_16x16x32_bf16 v[108:111], a[144:147], v[120:123], v[108:111]
    buffer_load_dwordx4 v4, s[20:23], s60 offen lds
    v_mul_f32 v76, v76, v242
    v_mfma_f32_16x16x32_bf16 v[116:119], a[154:157], v[120:123], v[116:119]
    v_mul_f32 v77, v77, v242
    v_cvt_pk_bf16_f32 v114, v76, v77
    v_mfma_f32_16x16x32_bf16 v[124:127], a[164:167], v[120:123], v[124:127]
    v_mul_f32 v78, v78, v242
    v_mul_f32 v79, v79, v242
    v_mfma_f32_16x16x32_bf16 v[132:135], a[174:177], v[120:123], v[132:135]
    v_cvt_pk_bf16_f32 v115, v78, v79
    v_mul_f32 v84, v84, v242
    v_mfma_f32_16x16x32_bf16 v[140:143], a[184:187], v[120:123], v[140:143]
    s_waitcnt vmcnt(14)
    ds_write_b128 v25, v[112:115] offset:8192
    v_mfma_f32_16x16x32_bf16 v[148:151], a[194:197], v[120:123], v[148:151]
    ds_read_b64_tr_b16 v[32:33], v12 offset:24576
    v_mul_f32 v85, v85, v242
    v_mfma_f32_16x16x16_bf16 v[156:159], v[232:233], v[160:161], v[156:159]
    s_add_u32 m0, s59, 37888
    ds_read_b64_tr_b16 v[34:35], v12 offset:26624
    v_cvt_pk_bf16_f32 v152, v84, v85
    v_mfma_f32_16x16x16_bf16 v[92:95], a[128:129], v[160:161], v[92:95]
    buffer_load_dwordx4 v5, s[20:23], s60 offen lds
    v_mul_f32 v86, v86, v242
    v_mfma_f32_16x16x16_bf16 v[100:103], a[138:139], v[160:161], v[100:103]
    v_mul_f32 v87, v87, v242
    v_cvt_pk_bf16_f32 v153, v86, v87
    v_mfma_f32_16x16x16_bf16 v[108:111], a[148:149], v[160:161], v[108:111]
    v_mul_f32 v164, v164, v242
    v_mul_f32 v165, v165, v242
    v_mfma_f32_16x16x16_bf16 v[116:119], a[158:159], v[160:161], v[116:119]
    ds_read_b64_tr_b16 v[36:37], v13 offset:24576
    v_cvt_pk_bf16_f32 v154, v164, v165
    v_mfma_f32_16x16x16_bf16 v[124:127], a[168:169], v[160:161], v[124:127]
    ds_read_b64_tr_b16 v[38:39], v13 offset:26624
    v_mul_f32 v166, v166, v242
    v_mfma_f32_16x16x16_bf16 v[132:135], a[178:179], v[160:161], v[132:135]
    v_mul_f32 v167, v167, v242
    v_cvt_pk_bf16_f32 v155, v166, v167
    v_mfma_f32_16x16x16_bf16 v[140:143], a[188:189], v[160:161], v[140:143]
    s_add_u32 m0, s59, 38912
    ds_write_b128 v25, v[152:155] offset:13312
    v_mfma_f32_16x16x16_bf16 v[148:151], a[198:199], v[160:161], v[148:151]
    s_waitcnt lgkmcnt(3)
    buffer_load_dwordx4 v6, s[20:23], s60 offen lds
    v_mul_f32 v172, v172, v242
    v_mul_f32 v173, v173, v242
    v_cvt_pk_bf16_f32 v192, v172, v173
    v_mul_f32 v174, v174, v242
    v_mul_f32 v175, v175, v242
    v_cvt_pk_bf16_f32 v193, v174, v175
    v_pk_mul_f32 v[180:181], v[180:181], v[242:243] op_sel_hi:[1,0]
    v_cvt_pk_bf16_f32 v194, v180, v181
    v_pk_mul_f32 v[182:183], v[182:183], v[242:243] op_sel_hi:[1,0]
    v_cvt_pk_bf16_f32 v195, v182, v183
    ds_write_b128 v25, v[192:195] offset:18432
    v_mfma_f32_16x16x32_bf16 v[208:211], v[32:35], v[48:51], 0
    ds_read_b64_tr_b16 v[40:41], v14 offset:24576
    v_mfma_f32_16x16x32_bf16 v[212:215], v[32:35], v[56:59], 0
    ds_read_b64_tr_b16 v[42:43], v14 offset:26624
    v_mfma_f32_16x16x32_bf16 v[216:219], v[32:35], v[64:67], 0
    v_rcp_f32 v242, v156
    s_nop 0
    v_mul_f32 v92, v92, v242
    v_mul_f32 v93, v93, v242
    v_cvt_pk_bf16_f32 v80, v92, v93
    v_mul_f32 v94, v94, v242
    v_mul_f32 v95, v95, v242
    v_cvt_pk_bf16_f32 v81, v94, v95
    v_pk_mul_f32 v[100:101], v[100:101], v[242:243] op_sel_hi:[1,0]
    v_cvt_pk_bf16_f32 v82, v100, v101
    v_pk_mul_f32 v[102:103], v[102:103], v[242:243] op_sel_hi:[1,0]
    v_cvt_pk_bf16_f32 v83, v102, v103
    ds_write_b128 v25, v[80:83] offset:4096
    v_mfma_f32_16x16x32_bf16 v[220:223], v[32:35], v[72:75], 0
    v_mul_f32 v108, v108, v242
    v_mul_f32 v109, v109, v242
    v_mfma_f32_16x16x32_bf16 v[224:227], v[32:35], v[80:83], 0
    s_waitcnt lgkmcnt(5)
    v_cvt_pk_bf16_f32 v120, v108, v109
    v_mul_f32 v110, v110, v242
    v_mfma_f32_16x16x32_bf16 v[228:231], v[36:39], v[48:51], 0
    ds_read_b64_tr_b16 v[44:45], v15 offset:24576
    v_mul_f32 v111, v111, v242
    v_mfma_f32_16x16x32_bf16 v[196:199], v[36:39], v[56:59], 0
    s_add_u32 m0, s59, 39936
    ds_read_b64_tr_b16 v[46:47], v15 offset:26624
    v_cvt_pk_bf16_f32 v121, v110, v111
    v_mfma_f32_16x16x32_bf16 v[204:207], v[36:39], v[64:67], 0
    buffer_load_dwordx4 v7, s[20:23], s60 offen lds
    v_mul_f32 v116, v116, v242
    v_mfma_f32_16x16x32_bf16 v[52:55], v[36:39], v[72:75], 0
    v_mul_f32 v117, v117, v242
    v_cvt_pk_bf16_f32 v122, v116, v117
    v_mfma_f32_16x16x32_bf16 v[60:63], v[36:39], v[80:83], 0
    s_waitcnt vmcnt(12)
    s_waitcnt lgkmcnt(3)
    v_mul_f32 v118, v118, v242
    v_mfma_f32_16x16x32_bf16 v[68:71], v[40:43], v[48:51], 0
    ds_read_b64_tr_b16 v[32:33], v12 offset:20480
    v_mul_f32 v119, v119, v242
    v_mfma_f32_16x16x32_bf16 v[76:79], v[40:43], v[56:59], 0
    ds_read_b64_tr_b16 v[34:35], v12 offset:22528
    v_cvt_pk_bf16_f32 v123, v118, v119
    v_mfma_f32_16x16x32_bf16 v[84:87], v[40:43], v[64:67], 0
    ds_write_b128 v25, v[120:123] offset:9216
    v_mfma_f32_16x16x32_bf16 v[164:167], v[40:43], v[72:75], 0
    v_mul_f32 v124, v124, v242
    v_mul_f32 v125, v125, v242
    v_mfma_f32_16x16x32_bf16 v[172:175], v[40:43], v[80:83], 0
    s_waitcnt lgkmcnt(3)
    v_cvt_pk_bf16_f32 v160, v124, v125
    v_mul_f32 v126, v126, v242
    v_mul_f32 v127, v127, v242
    v_cvt_pk_bf16_f32 v161, v126, v127
    v_mul_f32 v132, v132, v242
    v_mul_f32 v133, v133, v242
    v_cvt_pk_bf16_f32 v162, v132, v133
    v_pk_mul_f32 v[134:135], v[134:135], v[242:243] op_sel_hi:[1,0]
    v_cvt_pk_bf16_f32 v163, v134, v135
    ds_write_b128 v25, v[160:163] offset:14336
    v_pk_mul_f32 v[140:141], v[140:141], v[242:243] op_sel_hi:[1,0]
    v_cvt_pk_bf16_f32 v200, v140, v141
    v_pk_mul_f32 v[142:143], v[142:143], v[242:243] op_sel_hi:[1,0]
    v_cvt_pk_bf16_f32 v201, v142, v143
    v_pk_mul_f32 v[148:149], v[148:149], v[242:243] op_sel_hi:[1,0]
    v_cvt_pk_bf16_f32 v202, v148, v149
    v_pk_mul_f32 v[150:151], v[150:151], v[242:243] op_sel_hi:[1,0]
    v_cvt_pk_bf16_f32 v203, v150, v151
    ds_write_b128 v25, v[200:203] offset:19456
    v_mfma_f32_16x16x32_bf16 v[180:183], v[44:47], v[48:51], 0
    ds_read_b64_tr_b16 v[36:37], v13 offset:20480
    v_mfma_f32_16x16x32_bf16 v[188:191], v[44:47], v[56:59], 0
    s_add_u32 s60, s62, 32768
    ds_read_b64_tr_b16 v[38:39], v13 offset:22528
    s_add_u32 m0, s59, 24576
    v_mfma_f32_16x16x32_bf16 v[92:95], v[44:47], v[64:67], 0
    buffer_load_dwordx4 v4, s[20:23], s60 offen lds
    v_mfma_f32_16x16x32_bf16 v[100:103], v[44:47], v[72:75], 0
    s_add_u32 m0, s59, 25600
    v_mfma_f32_16x16x32_bf16 v[108:111], v[44:47], v[80:83], 0
    s_waitcnt lgkmcnt(5)
    buffer_load_dwordx4 v5, s[20:23], s60 offen lds
    v_mfma_f32_16x16x32_bf16 v[208:211], v[32:35], v[88:91], v[208:211]
    ds_read_b64_tr_b16 v[40:41], v14 offset:20480
    v_mfma_f32_16x16x32_bf16 v[212:215], v[32:35], v[96:99], v[212:215]
    s_add_u32 m0, s59, 26624
    ds_read_b64_tr_b16 v[42:43], v14 offset:22528
    v_mfma_f32_16x16x32_bf16 v[216:219], v[32:35], v[104:107], v[216:219]
    buffer_load_dwordx4 v6, s[20:23], s60 offen lds
    v_mfma_f32_16x16x32_bf16 v[220:223], v[32:35], v[112:115], v[220:223]
    s_add_u32 m0, s59, 27648
    v_mfma_f32_16x16x32_bf16 v[224:227], v[32:35], v[120:123], v[224:227]
    s_waitcnt lgkmcnt(2)
    buffer_load_dwordx4 v7, s[20:23], s60 offen lds
    v_mfma_f32_16x16x32_bf16 v[228:231], v[36:39], v[88:91], v[228:231]
    ds_read_b64_tr_b16 v[44:45], v15 offset:20480
    v_mfma_f32_16x16x32_bf16 v[196:199], v[36:39], v[96:99], v[196:199]
    ds_read_b64_tr_b16 v[46:47], v15 offset:22528
    v_mfma_f32_16x16x32_bf16 v[204:207], v[36:39], v[104:107], v[204:207]
    v_mfma_f32_16x16x32_bf16 v[52:55], v[36:39], v[112:115], v[52:55]
    v_mfma_f32_16x16x32_bf16 v[60:63], v[36:39], v[120:123], v[60:63]
    s_waitcnt vmcnt(12)
    s_waitcnt lgkmcnt(2)
    v_mfma_f32_16x16x32_bf16 v[68:71], v[40:43], v[88:91], v[68:71]
    ds_read_b64_tr_b16 v[32:33], v12 offset:28672
    v_mfma_f32_16x16x32_bf16 v[76:79], v[40:43], v[96:99], v[76:79]
    ds_read_b64_tr_b16 v[34:35], v12 offset:30720
    v_mfma_f32_16x16x32_bf16 v[84:87], v[40:43], v[104:107], v[84:87]
    v_mfma_f32_16x16x32_bf16 v[164:167], v[40:43], v[112:115], v[164:167]
    v_mfma_f32_16x16x32_bf16 v[172:175], v[40:43], v[120:123], v[172:175]
    s_waitcnt lgkmcnt(2)
    v_mfma_f32_16x16x32_bf16 v[180:183], v[44:47], v[88:91], v[180:183]
    ds_read_b64_tr_b16 v[36:37], v13 offset:28672
    v_mfma_f32_16x16x32_bf16 v[188:191], v[44:47], v[96:99], v[188:191]
    s_add_u32 s60, s62, 65536
    ds_read_b64_tr_b16 v[38:39], v13 offset:30720
    s_add_u32 m0, s59, 20480
    v_mfma_f32_16x16x32_bf16 v[92:95], v[44:47], v[104:107], v[92:95]
    buffer_load_dwordx4 v4, s[20:23], s60 offen lds
    v_mfma_f32_16x16x32_bf16 v[100:103], v[44:47], v[112:115], v[100:103]
    s_add_u32 m0, s59, 21504
    v_mfma_f32_16x16x32_bf16 v[108:111], v[44:47], v[120:123], v[108:111]
    s_waitcnt lgkmcnt(2)
    buffer_load_dwordx4 v5, s[20:23], s60 offen lds
    s_barrier
    v_mfma_f32_16x16x32_bf16 v[208:211], v[32:35], v[128:131], v[208:211]
    ds_read_b64_tr_b16 v[40:41], v14 offset:28672
    v_mfma_f32_16x16x32_bf16 v[212:215], v[32:35], v[136:139], v[212:215]
    s_add_u32 m0, s59, 22528
    ds_read_b64_tr_b16 v[42:43], v14 offset:30720
    v_mfma_f32_16x16x32_bf16 v[216:219], v[32:35], v[144:147], v[216:219]
    buffer_load_dwordx4 v6, s[20:23], s60 offen lds
    v_mfma_f32_16x16x32_bf16 v[220:223], v[32:35], v[152:155], v[220:223]
    s_add_u32 m0, s59, 23552
    v_mfma_f32_16x16x32_bf16 v[224:227], v[32:35], v[160:163], v[224:227]
    s_waitcnt lgkmcnt(2)
    buffer_load_dwordx4 v7, s[20:23], s60 offen lds
    v_mfma_f32_16x16x32_bf16 v[228:231], v[36:39], v[128:131], v[228:231]
    ds_read_b64_tr_b16 v[44:45], v15 offset:28672
    v_mfma_f32_16x16x32_bf16 v[196:199], v[36:39], v[136:139], v[196:199]
    ds_read_b64_tr_b16 v[46:47], v15 offset:30720
    v_mfma_f32_16x16x32_bf16 v[204:207], v[36:39], v[144:147], v[204:207]
    v_mfma_f32_16x16x32_bf16 v[52:55], v[36:39], v[152:155], v[52:55]
    v_mfma_f32_16x16x32_bf16 v[60:63], v[36:39], v[160:163], v[60:63]
    s_waitcnt vmcnt(12)
    s_waitcnt lgkmcnt(2)
    v_mfma_f32_16x16x32_bf16 v[68:71], v[40:43], v[128:131], v[68:71]
    ds_read_b64_tr_b16 v[32:33], v12 offset:32768
    v_mfma_f32_16x16x32_bf16 v[76:79], v[40:43], v[136:139], v[76:79]
    ds_read_b64_tr_b16 v[34:35], v12 offset:34816
    v_mfma_f32_16x16x32_bf16 v[84:87], v[40:43], v[144:147], v[84:87]
    v_mfma_f32_16x16x32_bf16 v[164:167], v[40:43], v[152:155], v[164:167]
    v_mfma_f32_16x16x32_bf16 v[172:175], v[40:43], v[160:163], v[172:175]
    s_waitcnt lgkmcnt(2)
    v_mfma_f32_16x16x32_bf16 v[180:183], v[44:47], v[128:131], v[180:183]
    ds_read_b64_tr_b16 v[36:37], v13 offset:32768
    v_mfma_f32_16x16x32_bf16 v[188:191], v[44:47], v[136:139], v[188:191]
    s_add_u32 s60, s62, 98304
    ds_read_b64_tr_b16 v[38:39], v13 offset:34816
    s_add_u32 m0, s59, 28672
    v_mfma_f32_16x16x32_bf16 v[92:95], v[44:47], v[144:147], v[92:95]
    buffer_load_dwordx4 v4, s[20:23], s60 offen lds
    v_mfma_f32_16x16x32_bf16 v[100:103], v[44:47], v[152:155], v[100:103]
    s_add_u32 m0, s59, 29696
    v_mfma_f32_16x16x32_bf16 v[108:111], v[44:47], v[160:163], v[108:111]
    s_waitcnt lgkmcnt(2)
    buffer_load_dwordx4 v5, s[20:23], s60 offen lds
    v_mfma_f32_16x16x32_bf16 v[208:211], v[32:35], v[168:171], v[208:211]
    ds_read_b64_tr_b16 v[40:41], v14 offset:32768
    v_mfma_f32_16x16x32_bf16 v[212:215], v[32:35], v[176:179], v[212:215]
    ds_read_b64_tr_b16 v[42:43], v14 offset:34816
    v_mfma_f32_16x16x32_bf16 v[216:219], v[32:35], v[184:187], v[216:219]
    s_add_u32 m0, s59, 30720
    ds_read_b128 a[16:19], v26 offset:0
    v_mfma_f32_16x16x32_bf16 v[220:223], v[32:35], v[192:195], v[220:223]
    buffer_load_dwordx4 v6, s[20:23], s60 offen lds
    v_mfma_f32_16x16x32_bf16 v[224:227], v[32:35], v[200:203], v[224:227]
    s_waitcnt lgkmcnt(3)
    ds_read_b128 a[20:23], v26 offset:1024
    v_mfma_f32_16x16x32_bf16 v[228:231], v[36:39], v[168:171], v[228:231]
    ds_read_b64_tr_b16 v[44:45], v15 offset:32768
    v_mfma_f32_16x16x32_bf16 v[196:199], v[36:39], v[176:179], v[196:199]
    ds_read_b64_tr_b16 v[46:47], v15 offset:34816
    v_mfma_f32_16x16x32_bf16 v[204:207], v[36:39], v[184:187], v[204:207]
    s_add_u32 m0, s59, 31744
    ds_read_b128 a[24:27], v26 offset:2048
    v_mfma_f32_16x16x32_bf16 v[52:55], v[36:39], v[192:195], v[52:55]
    buffer_load_dwordx4 v7, s[20:23], s60 offen lds
    v_mfma_f32_16x16x32_bf16 v[60:63], v[36:39], v[200:203], v[60:63]
    s_waitcnt vmcnt(12)
    s_waitcnt lgkmcnt(5)
    ds_read_b128 a[28:31], v26 offset:3072
    v_mfma_f32_16x16x32_bf16 v[68:71], v[40:43], v[168:171], v[68:71]
    ds_read_b64_tr_b16 v[32:33], v12 offset:36864
    v_mfma_f32_16x16x32_bf16 v[76:79], v[40:43], v[176:179], v[76:79]
    ds_read_b64_tr_b16 v[34:35], v12 offset:38912
    v_mfma_f32_16x16x32_bf16 v[84:87], v[40:43], v[184:187], v[84:87]
    ds_read_b128 a[32:35], v26 offset:4096
    v_mfma_f32_16x16x32_bf16 v[164:167], v[40:43], v[192:195], v[164:167]
    v_mfma_f32_16x16x32_bf16 v[172:175], v[40:43], v[200:203], v[172:175]
    s_waitcnt lgkmcnt(5)
    ds_read_b128 a[76:79], v26 offset:5120
    v_mfma_f32_16x16x32_bf16 v[180:183], v[44:47], v[168:171], v[180:183]
    ds_read_b64_tr_b16 v[36:37], v13 offset:36864
    v_mfma_f32_16x16x32_bf16 v[188:191], v[44:47], v[176:179], v[188:191]
    ds_read_b64_tr_b16 v[38:39], v13 offset:38912
    v_mfma_f32_16x16x32_bf16 v[92:95], v[44:47], v[184:187], v[92:95]
    s_add_u32 s60, s63, 0
    ds_read_b128 a[80:83], v26 offset:6144
    s_add_u32 m0, s59, 32768
    v_mfma_f32_16x16x32_bf16 v[100:103], v[44:47], v[192:195], v[100:103]
    buffer_load_dwordx4 v4, s[20:23], s60 offen lds
    v_mfma_f32_16x16x32_bf16 v[108:111], v[44:47], v[200:203], v[108:111]
    s_waitcnt lgkmcnt(5)
    s_waitcnt lgkmcnt(4)
    ds_read_b128 a[84:87], v26 offset:7168
    v_mfma_f32_16x16x32_bf16 v[208:211], v[32:35], a[16:19], v[208:211]
    ds_read_b64_tr_b16 v[40:41], v14 offset:36864
    v_mfma_f32_16x16x32_bf16 v[212:215], v[32:35], a[20:23], v[212:215]
    ds_read_b64_tr_b16 v[42:43], v14 offset:38912
    v_mfma_f32_16x16x32_bf16 v[216:219], v[32:35], a[24:27], v[216:219]
    s_add_u32 m0, s59, 33792
    ds_read_b128 a[88:91], v26 offset:8192
    v_mfma_f32_16x16x32_bf16 v[220:223], v[32:35], a[28:31], v[220:223]
    buffer_load_dwordx4 v5, s[20:23], s60 offen lds
    v_mfma_f32_16x16x32_bf16 v[224:227], v[32:35], a[32:35], v[224:227]
    s_waitcnt lgkmcnt(5)
    ds_read_b128 a[92:95], v26 offset:9216
    v_mfma_f32_16x16x32_bf16 v[228:231], v[36:39], a[16:19], v[228:231]
    ds_read_b64_tr_b16 v[44:45], v15 offset:36864
    v_mfma_f32_16x16x32_bf16 v[196:199], v[36:39], a[20:23], v[196:199]
    ds_read_b64_tr_b16 v[46:47], v15 offset:38912
    v_mfma_f32_16x16x32_bf16 v[204:207], v[36:39], a[24:27], v[204:207]
    s_add_u32 m0, s59, 34816
    ds_read_b128 a[136:139], v26 offset:10240
    v_mfma_f32_16x16x32_bf16 v[52:55], v[36:39], a[28:31], v[52:55]
    buffer_load_dwordx4 v6, s[20:23], s60 offen lds
    v_mfma_f32_16x16x32_bf16 v[60:63], v[36:39], a[32:35], v[60:63]
    s_waitcnt vmcnt(11)
    s_waitcnt lgkmcnt(5)
    ds_read_b128 a[140:143], v26 offset:11264
    v_mfma_f32_16x16x32_bf16 v[68:71], v[40:43], a[16:19], v[68:71]
    ds_read_b64_tr_b16 v[32:33], v12 offset:24576
    v_mfma_f32_16x16x32_bf16 v[76:79], v[40:43], a[20:23], v[76:79]
    ds_read_b64_tr_b16 v[34:35], v12 offset:26624
    v_mfma_f32_16x16x32_bf16 v[84:87], v[40:43], a[24:27], v[84:87]
    s_add_u32 m0, s59, 35840
    ds_read_b128 a[144:147], v26 offset:12288
    v_mfma_f32_16x16x32_bf16 v[164:167], v[40:43], a[28:31], v[164:167]
    buffer_load_dwordx4 v7, s[20:23], s60 offen lds
    v_mfma_f32_16x16x32_bf16 v[172:175], v[40:43], a[32:35], v[172:175]
    s_waitcnt lgkmcnt(5)
    ds_read_b128 a[148:151], v26 offset:13312
    v_mfma_f32_16x16x32_bf16 v[180:183], v[44:47], a[16:19], v[180:183]
    ds_read_b64_tr_b16 v[36:37], v13 offset:24576
    v_mfma_f32_16x16x32_bf16 v[188:191], v[44:47], a[20:23], v[188:191]
    ds_read_b64_tr_b16 v[38:39], v13 offset:26624
    v_mfma_f32_16x16x32_bf16 v[92:95], v[44:47], a[24:27], v[92:95]
    s_add_u32 s60, s63, 32768
    ds_read_b128 a[152:155], v26 offset:14336
    s_add_u32 m0, s59, 36864
    v_mfma_f32_16x16x32_bf16 v[100:103], v[44:47], a[28:31], v[100:103]
    buffer_load_dwordx4 v4, s[20:23], s60 offen lds
    v_mfma_f32_16x16x32_bf16 v[108:111], v[44:47], a[32:35], v[108:111]
    s_waitcnt lgkmcnt(5)
    ds_read_b128 a[196:199], v26 offset:15360
    v_mfma_f32_16x16x32_bf16 v[208:211], v[32:35], a[76:79], v[208:211]
    ds_read_b64_tr_b16 v[40:41], v14 offset:24576
    v_mfma_f32_16x16x32_bf16 v[212:215], v[32:35], a[80:83], v[212:215]
    ds_read_b64_tr_b16 v[42:43], v14 offset:26624
    v_mfma_f32_16x16x32_bf16 v[216:219], v[32:35], a[84:87], v[216:219]
    s_add_u32 m0, s59, 37888
    ds_read_b128 a[200:203], v26 offset:16384
    v_mfma_f32_16x16x32_bf16 v[220:223], v[32:35], a[88:91], v[220:223]
    buffer_load_dwordx4 v5, s[20:23], s60 offen lds
    v_mfma_f32_16x16x32_bf16 v[224:227], v[32:35], a[92:95], v[224:227]
    s_waitcnt lgkmcnt(5)
    ds_read_b128 a[204:207], v26 offset:17408
    v_mfma_f32_16x16x32_bf16 v[228:231], v[36:39], a[76:79], v[228:231]
    ds_read_b64_tr_b16 v[44:45], v15 offset:24576
    v_mfma_f32_16x16x32_bf16 v[196:199], v[36:39], a[80:83], v[196:199]
    ds_read_b64_tr_b16 v[46:47], v15 offset:26624
    v_mfma_f32_16x16x32_bf16 v[204:207], v[36:39], a[84:87], v[204:207]
    s_add_u32 m0, s59, 38912
    ds_read_b128 a[208:211], v26 offset:18432
    v_mfma_f32_16x16x32_bf16 v[52:55], v[36:39], a[88:91], v[52:55]
    buffer_load_dwordx4 v6, s[20:23], s60 offen lds
    v_mfma_f32_16x16x32_bf16 v[60:63], v[36:39], a[92:95], v[60:63]
    s_waitcnt vmcnt(11)
    s_waitcnt lgkmcnt(5)
    ds_read_b128 a[212:215], v26 offset:19456
    v_mfma_f32_16x16x32_bf16 v[68:71], v[40:43], a[76:79], v[68:71]
    ds_read_b64_tr_b16 v[32:33], v12 offset:20480
    v_mfma_f32_16x16x32_bf16 v[76:79], v[40:43], a[80:83], v[76:79]
    ds_read_b64_tr_b16 v[34:35], v12 offset:22528
    v_mfma_f32_16x16x32_bf16 v[84:87], v[40:43], a[84:87], v[84:87]
    s_add_u32 m0, s59, 39936
    ds_read_b128 a[36:39], v27 offset:0
    v_mfma_f32_16x16x32_bf16 v[164:167], v[40:43], a[88:91], v[164:167]
    buffer_load_dwordx4 v7, s[20:23], s60 offen lds
    v_mfma_f32_16x16x32_bf16 v[172:175], v[40:43], a[92:95], v[172:175]
    s_waitcnt lgkmcnt(5)
    ds_read_b128 a[40:43], v27 offset:1024
    v_mfma_f32_16x16x32_bf16 v[180:183], v[44:47], a[76:79], v[180:183]
    ds_read_b64_tr_b16 v[36:37], v13 offset:20480
    v_mfma_f32_16x16x32_bf16 v[188:191], v[44:47], a[80:83], v[188:191]
    ds_read_b64_tr_b16 v[38:39], v13 offset:22528
    v_mfma_f32_16x16x32_bf16 v[92:95], v[44:47], a[84:87], v[92:95]
    s_add_u32 s60, s63, 65536
    ds_read_b128 a[44:47], v27 offset:2048
    s_add_u32 m0, s59, 24576
    v_mfma_f32_16x16x32_bf16 v[100:103], v[44:47], a[88:91], v[100:103]
    buffer_load_dwordx4 v4, s[20:23], s60 offen lds
    v_mfma_f32_16x16x32_bf16 v[108:111], v[44:47], a[92:95], v[108:111]
    s_waitcnt lgkmcnt(5)
    ds_read_b128 a[48:51], v27 offset:3072
    v_mfma_f32_16x16x32_bf16 v[208:211], v[32:35], a[136:139], v[208:211]
    ds_read_b64_tr_b16 v[40:41], v14 offset:20480
    v_mfma_f32_16x16x32_bf16 v[212:215], v[32:35], a[140:143], v[212:215]
    ds_read_b64_tr_b16 v[42:43], v14 offset:22528
    v_mfma_f32_16x16x32_bf16 v[216:219], v[32:35], a[144:147], v[216:219]
    s_add_u32 m0, s59, 25600
    ds_read_b128 a[52:55], v27 offset:4096
    v_mfma_f32_16x16x32_bf16 v[220:223], v[32:35], a[148:151], v[220:223]
    buffer_load_dwordx4 v5, s[20:23], s60 offen lds
    v_mfma_f32_16x16x32_bf16 v[224:227], v[32:35], a[152:155], v[224:227]
    s_waitcnt lgkmcnt(5)
    ds_read_b128 a[96:99], v27 offset:5120
    v_mfma_f32_16x16x32_bf16 v[228:231], v[36:39], a[136:139], v[228:231]
    ds_read_b64_tr_b16 v[44:45], v15 offset:20480
    v_mfma_f32_16x16x32_bf16 v[196:199], v[36:39], a[140:143], v[196:199]
    ds_read_b64_tr_b16 v[46:47], v15 offset:22528
    v_mfma_f32_16x16x32_bf16 v[204:207], v[36:39], a[144:147], v[204:207]
    s_add_u32 m0, s59, 26624
    ds_read_b128 a[100:103], v27 offset:6144
    v_mfma_f32_16x16x32_bf16 v[52:55], v[36:39], a[148:151], v[52:55]
    buffer_load_dwordx4 v6, s[20:23], s60 offen lds
    v_mfma_f32_16x16x32_bf16 v[60:63], v[36:39], a[152:155], v[60:63]
    s_waitcnt vmcnt(11)
    s_waitcnt lgkmcnt(5)
    ds_read_b128 a[104:107], v27 offset:7168
    v_mfma_f32_16x16x32_bf16 v[68:71], v[40:43], a[136:139], v[68:71]
    ds_read_b64_tr_b16 v[32:33], v12 offset:28672
    v_mfma_f32_16x16x32_bf16 v[76:79], v[40:43], a[140:143], v[76:79]
    ds_read_b64_tr_b16 v[34:35], v12 offset:30720
    v_mfma_f32_16x16x32_bf16 v[84:87], v[40:43], a[144:147], v[84:87]
    s_add_u32 m0, s59, 27648
    ds_read_b128 a[108:111], v27 offset:8192
    v_mfma_f32_16x16x32_bf16 v[164:167], v[40:43], a[148:151], v[164:167]
    buffer_load_dwordx4 v7, s[20:23], s60 offen lds
    v_mfma_f32_16x16x32_bf16 v[172:175], v[40:43], a[152:155], v[172:175]
    s_waitcnt lgkmcnt(5)
    ds_read_b128 a[112:115], v27 offset:9216
    v_mfma_f32_16x16x32_bf16 v[180:183], v[44:47], a[136:139], v[180:183]
    ds_read_b64_tr_b16 v[36:37], v13 offset:28672
    v_mfma_f32_16x16x32_bf16 v[188:191], v[44:47], a[140:143], v[188:191]
    ds_read_b64_tr_b16 v[38:39], v13 offset:30720
    v_mfma_f32_16x16x32_bf16 v[92:95], v[44:47], a[144:147], v[92:95]
    s_add_u32 s60, s63, 98304
    ds_read_b128 a[156:159], v27 offset:10240
    s_add_u32 m0, s59, 20480
    v_mfma_f32_16x16x32_bf16 v[100:103], v[44:47], a[148:151], v[100:103]
    buffer_load_dwordx4 v4, s[20:23], s60 offen lds
    v_mfma_f32_16x16x32_bf16 v[108:111], v[44:47], a[152:155], v[108:111]
    s_waitcnt lgkmcnt(5)
    ds_read_b128 a[160:163], v27 offset:11264
    v_mfma_f32_16x16x32_bf16 v[208:211], v[32:35], a[196:199], v[208:211]
    ds_read_b64_tr_b16 v[40:41], v14 offset:28672
    v_mfma_f32_16x16x32_bf16 v[212:215], v[32:35], a[200:203], v[212:215]
    ds_read_b64_tr_b16 v[42:43], v14 offset:30720
    v_mfma_f32_16x16x32_bf16 v[216:219], v[32:35], a[204:207], v[216:219]
    s_add_u32 m0, s59, 21504
    ds_read_b128 a[164:167], v27 offset:12288
    v_mfma_f32_16x16x32_bf16 v[220:223], v[32:35], a[208:211], v[220:223]
    buffer_load_dwordx4 v5, s[20:23], s60 offen lds
    v_mfma_f32_16x16x32_bf16 v[224:227], v[32:35], a[212:215], v[224:227]
    s_waitcnt lgkmcnt(5)
    ds_read_b128 a[168:171], v27 offset:13312
    v_mfma_f32_16x16x32_bf16 v[228:231], v[36:39], a[196:199], v[228:231]
    ds_read_b64_tr_b16 v[44:45], v15 offset:28672
    v_mfma_f32_16x16x32_bf16 v[196:199], v[36:39], a[200:203], v[196:199]
    ds_read_b64_tr_b16 v[46:47], v15 offset:30720
    v_mfma_f32_16x16x32_bf16 v[204:207], v[36:39], a[204:207], v[204:207]
    s_add_u32 m0, s59, 22528
    ds_read_b128 a[172:175], v27 offset:14336
    v_mfma_f32_16x16x32_bf16 v[52:55], v[36:39], a[208:211], v[52:55]
    buffer_load_dwordx4 v6, s[20:23], s60 offen lds
    v_mfma_f32_16x16x32_bf16 v[60:63], v[36:39], a[212:215], v[60:63]
    s_waitcnt vmcnt(11)
    s_waitcnt lgkmcnt(5)
    ds_read_b128 a[216:219], v27 offset:15360
    v_mfma_f32_16x16x32_bf16 v[68:71], v[40:43], a[196:199], v[68:71]
    ds_read_b64_tr_b16 v[32:33], v12 offset:32768
    v_mfma_f32_16x16x32_bf16 v[76:79], v[40:43], a[200:203], v[76:79]
    ds_read_b64_tr_b16 v[34:35], v12 offset:34816
    v_mfma_f32_16x16x32_bf16 v[84:87], v[40:43], a[204:207], v[84:87]
    s_add_u32 m0, s59, 23552
    ds_read_b128 a[220:223], v27 offset:16384
    v_mfma_f32_16x16x32_bf16 v[164:167], v[40:43], a[208:211], v[164:167]
    buffer_load_dwordx4 v7, s[20:23], s60 offen lds
    v_mfma_f32_16x16x32_bf16 v[172:175], v[40:43], a[212:215], v[172:175]
    s_waitcnt lgkmcnt(5)
    ds_read_b128 a[224:227], v27 offset:17408
    v_mfma_f32_16x16x32_bf16 v[180:183], v[44:47], a[196:199], v[180:183]
    ds_read_b64_tr_b16 v[36:37], v13 offset:32768
    v_mfma_f32_16x16x32_bf16 v[188:191], v[44:47], a[200:203], v[188:191]
    ds_read_b64_tr_b16 v[38:39], v13 offset:34816
    v_mfma_f32_16x16x32_bf16 v[92:95], v[44:47], a[204:207], v[92:95]
    s_add_u32 s60, s64, 0
    ds_read_b128 a[228:231], v27 offset:18432
    s_add_u32 m0, s59, 28672
    v_mfma_f32_16x16x32_bf16 v[100:103], v[44:47], a[208:211], v[100:103]
    buffer_load_dwordx4 v4, s[20:23], s60 offen lds
    v_mfma_f32_16x16x32_bf16 v[108:111], v[44:47], a[212:215], v[108:111]
    s_waitcnt lgkmcnt(5)
    ds_read_b128 a[232:235], v27 offset:19456
    v_mfma_f32_16x16x32_bf16 v[208:211], v[32:35], a[36:39], v[208:211]
    ds_read_b64_tr_b16 v[40:41], v14 offset:32768
    v_mfma_f32_16x16x32_bf16 v[212:215], v[32:35], a[40:43], v[212:215]
    ds_read_b64_tr_b16 v[42:43], v14 offset:34816
    v_mfma_f32_16x16x32_bf16 v[216:219], v[32:35], a[44:47], v[216:219]
    s_add_u32 m0, s59, 29696
    ds_read_b128 a[56:59], v28 offset:0
    v_mfma_f32_16x16x32_bf16 v[220:223], v[32:35], a[48:51], v[220:223]
    buffer_load_dwordx4 v5, s[20:23], s60 offen lds
    v_mfma_f32_16x16x32_bf16 v[224:227], v[32:35], a[52:55], v[224:227]
    s_waitcnt lgkmcnt(5)
    ds_read_b128 a[60:63], v28 offset:1024
    v_mfma_f32_16x16x32_bf16 v[228:231], v[36:39], a[36:39], v[228:231]
    ds_read_b64_tr_b16 v[44:45], v15 offset:32768
    v_mfma_f32_16x16x32_bf16 v[196:199], v[36:39], a[40:43], v[196:199]
    ds_read_b64_tr_b16 v[46:47], v15 offset:34816
    v_mfma_f32_16x16x32_bf16 v[204:207], v[36:39], a[44:47], v[204:207]
    s_add_u32 m0, s59, 30720
    ds_read_b128 a[64:67], v28 offset:2048
    v_mfma_f32_16x16x32_bf16 v[52:55], v[36:39], a[48:51], v[52:55]
    buffer_load_dwordx4 v6, s[20:23], s60 offen lds
    v_mfma_f32_16x16x32_bf16 v[60:63], v[36:39], a[52:55], v[60:63]
    s_waitcnt vmcnt(11)
    s_waitcnt lgkmcnt(5)
    ds_read_b128 a[68:71], v28 offset:3072
    v_mfma_f32_16x16x32_bf16 v[68:71], v[40:43], a[36:39], v[68:71]
    ds_read_b64_tr_b16 v[32:33], v12 offset:36864
    v_mfma_f32_16x16x32_bf16 v[76:79], v[40:43], a[40:43], v[76:79]
    ds_read_b64_tr_b16 v[34:35], v12 offset:38912
    v_mfma_f32_16x16x32_bf16 v[84:87], v[40:43], a[44:47], v[84:87]
    s_add_u32 m0, s59, 31744
    ds_read_b128 a[72:75], v28 offset:4096
    v_mfma_f32_16x16x32_bf16 v[164:167], v[40:43], a[48:51], v[164:167]
    buffer_load_dwordx4 v7, s[20:23], s60 offen lds
    v_mfma_f32_16x16x32_bf16 v[172:175], v[40:43], a[52:55], v[172:175]
    s_waitcnt lgkmcnt(5)
    ds_read_b128 a[116:119], v28 offset:5120
    v_mfma_f32_16x16x32_bf16 v[180:183], v[44:47], a[36:39], v[180:183]
    ds_read_b64_tr_b16 v[36:37], v13 offset:36864
    v_mfma_f32_16x16x32_bf16 v[188:191], v[44:47], a[40:43], v[188:191]
    ds_read_b64_tr_b16 v[38:39], v13 offset:38912
    v_mfma_f32_16x16x32_bf16 v[92:95], v[44:47], a[44:47], v[92:95]
    s_add_u32 s60, s64, 32768
    ds_read_b128 a[120:123], v28 offset:6144
    s_add_u32 m0, s59, 32768
    v_mfma_f32_16x16x32_bf16 v[100:103], v[44:47], a[48:51], v[100:103]
    buffer_load_dwordx4 v4, s[20:23], s60 offen lds
    v_mfma_f32_16x16x32_bf16 v[108:111], v[44:47], a[52:55], v[108:111]
    s_waitcnt lgkmcnt(5)
    ds_read_b128 a[124:127], v28 offset:7168
    v_mfma_f32_16x16x32_bf16 v[208:211], v[32:35], a[96:99], v[208:211]
    s_lshl_b32 s99, s54, 1
    ds_read_b64_tr_b16 v[40:41], v14 offset:36864
    v_lshrrev_b32 v16, 1, v2
    v_mfma_f32_16x16x32_bf16 v[212:215], v[32:35], a[100:103], v[212:215]
    ds_read_b64_tr_b16 v[42:43], v14 offset:38912
    v_add_u32 v16, s99, v16
    v_mfma_f32_16x16x32_bf16 v[216:219], v[32:35], a[104:107], v[216:219]
    s_add_u32 m0, s59, 33792
    ds_read_b128 a[128:131], v28 offset:8192
    v_and_b32 v17, 7, v3
    v_mfma_f32_16x16x32_bf16 v[220:223], v[32:35], a[108:111], v[220:223]
    buffer_load_dwordx4 v5, s[20:23], s60 offen lds
    v_xor_b32 v16, v16, v17
    v_mfma_f32_16x16x32_bf16 v[224:227], v[32:35], a[112:115], v[224:227]
    s_waitcnt lgkmcnt(5)
    ds_read_b128 a[132:135], v28 offset:9216
    v_lshlrev_b32 v16, 4, v16
    v_mfma_f32_16x16x32_bf16 v[228:231], v[36:39], a[96:99], v[228:231]
    ds_read_b64_tr_b16 v[44:45], v15 offset:36864
    v_lshl_add_u32 v16, v3, 7, v16
    v_mfma_f32_16x16x32_bf16 v[196:199], v[36:39], a[100:103], v[196:199]
    ds_read_b64_tr_b16 v[46:47], v15 offset:38912
    v_and_b32 v17, 1, v2
    v_mfma_f32_16x16x32_bf16 v[204:207], v[36:39], a[104:107], v[204:207]
    s_add_u32 m0, s59, 34816
    ds_read_b128 a[176:179], v28 offset:10240
    v_lshl_add_u32 v16, v17, 3, v16
    v_mfma_f32_16x16x32_bf16 v[52:55], v[36:39], a[108:111], v[52:55]
    s_lshl_b32 s99, s54, 10
    buffer_load_dwordx4 v6, s[20:23], s60 offen lds
    v_add_u32 v17, s99, v29
    v_mfma_f32_16x16x32_bf16 v[60:63], v[36:39], a[112:115], v[60:63]
    s_waitcnt vmcnt(11)
    s_waitcnt lgkmcnt(5)
    ds_read_b128 a[180:183], v28 offset:11264
    v_mfma_f32_16x16x32_bf16 v[68:71], v[40:43], a[96:99], v[68:71]
    ds_read_b64_tr_b16 v[32:33], v12 offset:24576
    v_lshrrev_b32 v18, 3, v1
    v_mfma_f32_16x16x32_bf16 v[76:79], v[40:43], a[100:103], v[76:79]
    ds_read_b64_tr_b16 v[34:35], v12 offset:26624
    v_and_b32 v19, 7, v1
    v_mfma_f32_16x16x32_bf16 v[84:87], v[40:43], a[104:107], v[84:87]
    s_add_u32 m0, s59, 35840
    ds_read_b128 a[184:187], v28 offset:12288
    v_xor_b32 v19, v19, v18
    v_mfma_f32_16x16x32_bf16 v[164:167], v[40:43], a[108:111], v[164:167]
    buffer_load_dwordx4 v7, s[20:23], s60 offen lds
    v_lshlrev_b32 v19, 4, v19
    v_mfma_f32_16x16x32_bf16 v[172:175], v[40:43], a[112:115], v[172:175]
    s_waitcnt lgkmcnt(5)
    ds_read_b128 a[188:191], v28 offset:13312
    v_lshl_add_u32 v18, v18, 11, v19
    v_mfma_f32_16x16x32_bf16 v[180:183], v[44:47], a[96:99], v[180:183]
    s_mul_i32 s99, s54, 16352
    ds_read_b64_tr_b16 v[36:37], v13 offset:24576
    v_mfma_f32_16x16x32_bf16 v[188:191], v[44:47], a[100:103], v[188:191]
    s_add_u32 s47, s47, s99
    ds_read_b64_tr_b16 v[38:39], v13 offset:26624
    v_mfma_f32_16x16x32_bf16 v[92:95], v[44:47], a[104:107], v[92:95]
    s_add_u32 s60, s64, 65536
    ds_read_b128 a[192:195], v28 offset:14336
    s_add_u32 m0, s59, 36864
    v_mfma_f32_16x16x32_bf16 v[100:103], v[44:47], a[108:111], v[100:103]
    s_lshr_b32 s99, s54, 1
    buffer_load_dwordx4 v4, s[20:23], s60 offen lds
    v_mfma_f32_16x16x32_bf16 v[108:111], v[44:47], a[112:115], v[108:111]
    s_waitcnt lgkmcnt(5)
    ds_read_b128 a[236:239], v28 offset:15360
    v_mfma_f32_16x16x32_bf16 v[208:211], v[32:35], a[156:159], v[208:211]
    s_mul_i32 s99, s99, 0x70000000
    ds_read_b64_tr_b16 v[40:41], v14 offset:24576
    v_mfma_f32_16x16x32_bf16 v[212:215], v[32:35], a[160:163], v[212:215]
    s_add_u32 s46, s47, s99
    ds_read_b64_tr_b16 v[42:43], v14 offset:26624
    v_mfma_f32_16x16x32_bf16 v[216:219], v[32:35], a[164:167], v[216:219]
    s_add_u32 m0, s59, 37888
    ds_read_b128 a[240:243], v28 offset:16384
    v_mfma_f32_16x16x32_bf16 v[220:223], v[32:35], a[168:171], v[220:223]
    s_add_u32 s46, s46, 131072
    buffer_load_dwordx4 v5, s[20:23], s60 offen lds
    v_mfma_f32_16x16x32_bf16 v[224:227], v[32:35], a[172:175], v[224:227]
    s_waitcnt lgkmcnt(5)
    ds_read_b128 a[244:247], v28 offset:17408
    v_mfma_f32_16x16x32_bf16 v[228:231], v[36:39], a[156:159], v[228:231]
    ds_read_b64_tr_b16 v[44:45], v15 offset:24576
    v_mfma_f32_16x16x32_bf16 v[196:199], v[36:39], a[160:163], v[196:199]
    ds_read_b64_tr_b16 v[46:47], v15 offset:26624
    v_mfma_f32_16x16x32_bf16 v[204:207], v[36:39], a[164:167], v[204:207]
    s_add_u32 m0, s59, 38912
    ds_read_b128 a[248:251], v28 offset:18432
    v_mfma_f32_16x16x32_bf16 v[52:55], v[36:39], a[168:171], v[52:55]
    buffer_load_dwordx4 v6, s[20:23], s60 offen lds
    v_mfma_f32_16x16x32_bf16 v[60:63], v[36:39], a[172:175], v[60:63]
    s_waitcnt vmcnt(11)
    s_waitcnt lgkmcnt(5)
    ds_read_b128 a[252:255], v28 offset:19456
    v_mfma_f32_16x16x32_bf16 v[68:71], v[40:43], a[156:159], v[68:71]
    ds_read_b64_tr_b16 v[32:33], v12 offset:20480
    v_mfma_f32_16x16x32_bf16 v[76:79], v[40:43], a[160:163], v[76:79]
    s_add_u32 m0, s59, 39936
    ds_read_b64_tr_b16 v[34:35], v12 offset:22528
    v_mfma_f32_16x16x32_bf16 v[84:87], v[40:43], a[164:167], v[84:87]
    buffer_load_dwordx4 v7, s[20:23], s60 offen lds
    v_mfma_f32_16x16x32_bf16 v[164:167], v[40:43], a[168:171], v[164:167]
    buffer_load_dword v243, v250, s[32:35], 0 offen sc1
    v_mfma_f32_16x16x32_bf16 v[172:175], v[40:43], a[172:175], v[172:175]
    s_waitcnt lgkmcnt(4)
    v_mfma_f32_16x16x32_bf16 v[180:183], v[44:47], a[156:159], v[180:183]
    ds_read_b64_tr_b16 v[36:37], v13 offset:20480
    v_mfma_f32_16x16x32_bf16 v[188:191], v[44:47], a[160:163], v[188:191]
    s_add_u32 s60, s64, 98304
    ds_read_b64_tr_b16 v[38:39], v13 offset:22528
    s_add_u32 m0, s59, 24576
    v_mfma_f32_16x16x32_bf16 v[92:95], v[44:47], a[164:167], v[92:95]
    s_lshr_b32 s96, s54, 1
    buffer_load_dwordx4 v4, s[20:23], s60 offen lds
    s_add_u32 s96, s96, s56
    v_mfma_f32_16x16x32_bf16 v[100:103], v[44:47], a[168:171], v[100:103]
    s_add_u32 m0, s59, 25600
    s_add_u32 s96, s96, 5
    s_and_b32 s96, s96, 7
    v_mfma_f32_16x16x32_bf16 v[108:111], v[44:47], a[172:175], v[108:111]
    s_waitcnt lgkmcnt(2)
    buffer_load_dwordx4 v5, s[20:23], s60 offen lds
    s_barrier
    v_mfma_f32_16x16x32_bf16 v[208:211], v[32:35], a[216:219], v[208:211]
    s_lshl_b32 s96, s96, 7
    ds_read_b64_tr_b16 v[40:41], v14 offset:20480
    s_xor_b32 s61, s54, 0
    v_mfma_f32_16x16x32_bf16 v[212:215], v[32:35], a[220:223], v[212:215]
    s_add_u32 m0, s59, 26624
    ds_read_b64_tr_b16 v[42:43], v14 offset:22528
    s_lshl_b32 s61, s61, 17
    v_mfma_f32_16x16x32_bf16 v[216:219], v[32:35], a[224:227], v[216:219]
    s_add_u32 s61, s61, s96
    buffer_load_dwordx4 v6, s[20:23], s60 offen lds
    s_xor_b32 s63, s54, 2
    v_mfma_f32_16x16x32_bf16 v[220:223], v[32:35], a[228:231], v[220:223]
    s_add_u32 m0, s59, 27648
    s_lshl_b32 s63, s63, 17
    s_add_u32 s63, s63, s96
    v_mfma_f32_16x16x32_bf16 v[224:227], v[32:35], a[232:235], v[224:227]
    s_waitcnt lgkmcnt(2)
    buffer_load_dwordx4 v7, s[20:23], s60 offen lds
    v_mfma_f32_16x16x32_bf16 v[228:231], v[36:39], a[216:219], v[228:231]
    ds_read_b64_tr_b16 v[44:45], v15 offset:20480
    v_mfma_f32_16x16x32_bf16 v[196:199], v[36:39], a[220:223], v[196:199]
    ds_read_b64_tr_b16 v[46:47], v15 offset:22528
    v_mfma_f32_16x16x32_bf16 v[204:207], v[36:39], a[224:227], v[204:207]
    v_mfma_f32_16x16x32_bf16 v[52:55], v[36:39], a[228:231], v[52:55]
    v_mfma_f32_16x16x32_bf16 v[60:63], v[36:39], a[232:235], v[60:63]
    s_waitcnt vmcnt(13)
    s_waitcnt lgkmcnt(2)
    v_mfma_f32_16x16x32_bf16 v[68:71], v[40:43], a[216:219], v[68:71]
    ds_read_b64_tr_b16 v[32:33], v12 offset:28672
    v_mfma_f32_16x16x32_bf16 v[76:79], v[40:43], a[220:223], v[76:79]
    s_add_u32 s60, s61, 0
    ds_read_b64_tr_b16 v[34:35], v12 offset:30720
    s_add_u32 m0, s59, 0
    v_mfma_f32_16x16x32_bf16 v[84:87], v[40:43], a[224:227], v[84:87]
    buffer_load_dwordx4 v4, s[20:23], s60 offen lds
    v_mfma_f32_16x16x32_bf16 v[164:167], v[40:43], a[228:231], v[164:167]
    s_add_u32 m0, s59, 1024
    v_mfma_f32_16x16x32_bf16 v[172:175], v[40:43], a[232:235], v[172:175]
    s_waitcnt lgkmcnt(2)
    buffer_load_dwordx4 v5, s[20:23], s60 offen lds
    v_mfma_f32_16x16x32_bf16 v[180:183], v[44:47], a[216:219], v[180:183]
    ds_read_b64_tr_b16 v[36:37], v13 offset:28672
    v_mfma_f32_16x16x32_bf16 v[188:191], v[44:47], a[220:223], v[188:191]
    s_add_u32 m0, s59, 2048
    ds_read_b64_tr_b16 v[38:39], v13 offset:30720
    v_mfma_f32_16x16x32_bf16 v[92:95], v[44:47], a[224:227], v[92:95]
    buffer_load_dwordx4 v6, s[20:23], s60 offen lds
    v_mfma_f32_16x16x32_bf16 v[100:103], v[44:47], a[228:231], v[100:103]
    s_add_u32 m0, s59, 3072
    v_mfma_f32_16x16x32_bf16 v[108:111], v[44:47], a[232:235], v[108:111]
    s_waitcnt lgkmcnt(2)
    buffer_load_dwordx4 v7, s[20:23], s60 offen lds
    v_mfma_f32_16x16x32_bf16 v[208:211], v[32:35], a[56:59], v[208:211]
    ds_read_b64_tr_b16 v[40:41], v14 offset:28672
    v_mfma_f32_16x16x32_bf16 v[212:215], v[32:35], a[60:63], v[212:215]
    ds_read_b64_tr_b16 v[42:43], v14 offset:30720
    v_mfma_f32_16x16x32_bf16 v[216:219], v[32:35], a[64:67], v[216:219]
    v_mfma_f32_16x16x32_bf16 v[220:223], v[32:35], a[68:71], v[220:223]
    s_add_u32 s60, s61, 32768
    s_add_u32 m0, s59, 4096
    v_mfma_f32_16x16x32_bf16 v[224:227], v[32:35], a[72:75], v[224:227]
    s_waitcnt lgkmcnt(2)
    buffer_load_dwordx4 v4, s[20:23], s60 offen lds
    v_mfma_f32_16x16x32_bf16 v[228:231], v[36:39], a[56:59], v[228:231]
    ds_read_b64_tr_b16 v[44:45], v15 offset:28672
    v_mfma_f32_16x16x32_bf16 v[196:199], v[36:39], a[60:63], v[196:199]
    s_add_u32 m0, s59, 5120
    ds_read_b64_tr_b16 v[46:47], v15 offset:30720
    v_mfma_f32_16x16x32_bf16 v[204:207], v[36:39], a[64:67], v[204:207]
    buffer_load_dwordx4 v5, s[20:23], s60 offen lds
    v_mfma_f32_16x16x32_bf16 v[52:55], v[36:39], a[68:71], v[52:55]
    s_add_u32 m0, s59, 6144
    v_mfma_f32_16x16x32_bf16 v[60:63], v[36:39], a[72:75], v[60:63]
    s_waitcnt vmcnt(15)
    buffer_load_dwordx4 v6, s[20:23], s60 offen lds
    s_waitcnt lgkmcnt(2)
    v_mfma_f32_16x16x32_bf16 v[68:71], v[40:43], a[56:59], v[68:71]
    s_xor_b32 s100, s54, 0
    ds_read_b64_tr_b16 v[32:33], v12 offset:32768
    v_mfma_f32_16x16x32_bf16 v[76:79], v[40:43], a[60:63], v[76:79]
    s_add_u32 m0, s59, 7168
    ds_read_b64_tr_b16 v[34:35], v12 offset:34816
    v_mfma_f32_16x16x32_bf16 v[84:87], v[40:43], a[64:67], v[84:87]
    s_mul_i32 s100, s100, 40960
    buffer_load_dwordx4 v7, s[20:23], s60 offen lds
    v_mfma_f32_16x16x32_bf16 v[164:167], v[40:43], a[68:71], v[164:167]
    s_and_b32 s101, s54, 1
    v_mfma_f32_16x16x32_bf16 v[172:175], v[40:43], a[72:75], v[172:175]
    s_waitcnt lgkmcnt(2)
    v_mfma_f32_16x16x32_bf16 v[180:183], v[44:47], a[56:59], v[180:183]
    s_lshl_b32 s101, s101, 6
    ds_read_b64_tr_b16 v[36:37], v13 offset:32768
    v_mfma_f32_16x16x32_bf16 v[188:191], v[44:47], a[60:63], v[188:191]
    s_add_u32 s101, s101, 0
    ds_read_b64_tr_b16 v[38:39], v13 offset:34816
    v_xor_b32 v8, s101, v31
    v_mfma_f32_16x16x32_bf16 v[92:95], v[44:47], a[64:67], v[92:95]
    s_add_u32 s60, s61, 65536
    s_add_u32 m0, s59, 8192
    v_add_u32 v8, s100, v8
    v_mfma_f32_16x16x32_bf16 v[100:103], v[44:47], a[68:71], v[100:103]
    s_xor_b32 s100, s54, 0
    buffer_load_dwordx4 v4, s[20:23], s60 offen lds
    v_mfma_f32_16x16x32_bf16 v[108:111], v[44:47], a[72:75], v[108:111]
    s_waitcnt lgkmcnt(2)
    v_mfma_f32_16x16x32_bf16 v[208:211], v[32:35], a[116:119], v[208:211]
    s_mul_i32 s100, s100, 40960
    ds_read_b64_tr_b16 v[40:41], v14 offset:32768
    v_mfma_f32_16x16x32_bf16 v[212:215], v[32:35], a[120:123], v[212:215]
    s_add_u32 m0, s59, 9216
    ds_read_b64_tr_b16 v[42:43], v14 offset:34816
    v_mfma_f32_16x16x32_bf16 v[216:219], v[32:35], a[124:127], v[216:219]
    s_and_b32 s101, s54, 1
    buffer_load_dwordx4 v5, s[20:23], s60 offen lds
    v_mfma_f32_16x16x32_bf16 v[220:223], v[32:35], a[128:131], v[220:223]
    s_add_u32 m0, s59, 10240
    v_mfma_f32_16x16x32_bf16 v[224:227], v[32:35], a[132:135], v[224:227]
    s_waitcnt lgkmcnt(2)
    buffer_load_dwordx4 v6, s[20:23], s60 offen lds
    v_mfma_f32_16x16x32_bf16 v[228:231], v[36:39], a[116:119], v[228:231]
    s_lshl_b32 s101, s101, 6
    ds_read_b64_tr_b16 v[44:45], v15 offset:32768
    v_mfma_f32_16x16x32_bf16 v[196:199], v[36:39], a[120:123], v[196:199]
    s_add_u32 m0, s59, 11264
    ds_read_b64_tr_b16 v[46:47], v15 offset:34816
    v_mfma_f32_16x16x32_bf16 v[204:207], v[36:39], a[124:127], v[204:207]
    s_add_u32 s101, s101, 32
    buffer_load_dwordx4 v7, s[20:23], s60 offen lds
    v_xor_b32 v9, s101, v31
    v_mfma_f32_16x16x32_bf16 v[52:55], v[36:39], a[128:131], v[52:55]
    v_add_u32 v9, s100, v9
    s_xor_b32 s100, s54, 1
    v_mfma_f32_16x16x32_bf16 v[60:63], v[36:39], a[132:135], v[60:63]
    s_waitcnt vmcnt(17)
    s_waitcnt lgkmcnt(2)
    v_mfma_f32_16x16x32_bf16 v[68:71], v[40:43], a[116:119], v[68:71]
    s_mul_i32 s100, s100, 40960
    ds_read_b64_tr_b16 v[32:33], v12 offset:36864
    v_mfma_f32_16x16x32_bf16 v[76:79], v[40:43], a[120:123], v[76:79]
    s_add_u32 s60, s61, 98304
    ds_read_b64_tr_b16 v[34:35], v12 offset:38912
    s_add_u32 m0, s59, 12288
    v_mfma_f32_16x16x32_bf16 v[84:87], v[40:43], a[124:127], v[84:87]
    s_and_b32 s101, s54, 1
    buffer_load_dwordx4 v4, s[20:23], s60 offen lds
    v_mfma_f32_16x16x32_bf16 v[164:167], v[40:43], a[128:131], v[164:167]
    s_add_u32 m0, s59, 13312
    v_mfma_f32_16x16x32_bf16 v[172:175], v[40:43], a[132:135], v[172:175]
    s_waitcnt lgkmcnt(2)
    buffer_load_dwordx4 v5, s[20:23], s60 offen lds
    v_mfma_f32_16x16x32_bf16 v[180:183], v[44:47], a[116:119], v[180:183]
    s_lshl_b32 s101, s101, 6
    ds_read_b64_tr_b16 v[36:37], v13 offset:36864
    v_mfma_f32_16x16x32_bf16 v[188:191], v[44:47], a[120:123], v[188:191]
    s_add_u32 m0, s59, 14336
    ds_read_b64_tr_b16 v[38:39], v13 offset:38912
    v_mfma_f32_16x16x32_bf16 v[92:95], v[44:47], a[124:127], v[92:95]
    s_add_u32 s101, s101, 0
    buffer_load_dwordx4 v6, s[20:23], s60 offen lds
    v_xor_b32 v10, s101, v31
    v_mfma_f32_16x16x32_bf16 v[100:103], v[44:47], a[128:131], v[100:103]
    s_add_u32 m0, s59, 15360
    v_add_u32 v10, s100, v10
    v_mfma_f32_16x16x32_bf16 v[108:111], v[44:47], a[132:135], v[108:111]
    s_waitcnt lgkmcnt(2)
    buffer_load_dwordx4 v7, s[20:23], s60 offen lds
    v_mfma_f32_16x16x32_bf16 v[208:211], v[32:35], a[176:179], v[208:211]
    s_xor_b32 s100, s54, 1
    ds_read_b64_tr_b16 v[40:41], v14 offset:36864
    v_mfma_f32_16x16x32_bf16 v[212:215], v[32:35], a[180:183], v[212:215]
    s_mul_i32 s100, s100, 40960
    ds_read_b64_tr_b16 v[42:43], v14 offset:38912
    v_mfma_f32_16x16x32_bf16 v[216:219], v[32:35], a[184:187], v[216:219]
    s_and_b32 s101, s54, 1
    v_mfma_f32_16x16x32_bf16 v[220:223], v[32:35], a[188:191], v[220:223]
    s_lshl_b32 s101, s101, 6
    v_mfma_f32_16x16x32_bf16 v[224:227], v[32:35], a[192:195], v[224:227]
    s_waitcnt lgkmcnt(2)
    v_mfma_f32_16x16x32_bf16 v[228:231], v[36:39], a[176:179], v[228:231]
    s_add_u32 s101, s101, 32
    ds_read_b64_tr_b16 v[44:45], v15 offset:36864
    v_xor_b32 v11, s101, v31
    v_mfma_f32_16x16x32_bf16 v[196:199], v[36:39], a[180:183], v[196:199]
    s_add_u32 s60, s63, 0
    ds_read_b64_tr_b16 v[46:47], v15 offset:38912
    s_add_u32 m0, s59, 16384
    v_mfma_f32_16x16x32_bf16 v[204:207], v[36:39], a[184:187], v[204:207]
    s_lshr_b32 s97, s54, 0
    buffer_load_dwordx4 v4, s[20:23], s60 offen lds
    v_add_u32 v11, s100, v11
    v_mfma_f32_16x16x32_bf16 v[52:55], v[36:39], a[188:191], v[52:55]
    s_add_u32 m0, s59, 17408
    s_add_u32 s97, s97, 1
    s_add_u32 s98, s97, s56
    v_mfma_f32_16x16x32_bf16 v[60:63], v[36:39], a[192:195], v[60:63]
    s_waitcnt vmcnt(17)
    buffer_load_dwordx4 v5, s[20:23], s60 offen lds
    s_waitcnt lgkmcnt(2)
    v_mfma_f32_16x16x32_bf16 v[68:71], v[40:43], a[176:179], v[68:71]
    s_and_b32 s98, s98, 7
    ds_read_b64_tr_b16 v[32:33], v12 offset:24576
    s_lshl_b32 s99, s58, 3
    v_mfma_f32_16x16x32_bf16 v[76:79], v[40:43], a[180:183], v[76:79]
    s_add_u32 m0, s59, 18432
    ds_read_b64_tr_b16 v[34:35], v12 offset:26624
    s_add_u32 s98, s98, s99
    v_mfma_f32_16x16x32_bf16 v[84:87], v[40:43], a[184:187], v[84:87]
    s_lshl_b32 s73, s98, 3
    buffer_load_dwordx4 v6, s[20:23], s60 offen lds
    s_add_u32 s73, s73, s97
    v_mfma_f32_16x16x32_bf16 v[164:167], v[40:43], a[188:191], v[164:167]
    s_add_u32 m0, s59, 19456
    s_mul_i32 s73, s73, 10240
    s_lshl_b32 s98, s98, 7
    v_mfma_f32_16x16x32_bf16 v[172:175], v[40:43], a[192:195], v[172:175]
    s_waitcnt lgkmcnt(2)
    buffer_load_dwordx4 v7, s[20:23], s60 offen lds
    s_lshl_b32 s97, s97, 2
    v_mfma_f32_16x16x32_bf16 v[180:183], v[44:47], a[176:179], v[180:183]
    s_add_u32 s98, s98, s97
    ds_read_b64_tr_b16 v[36:37], v13 offset:24576
    s_add_u32 s74, s98, 33554432
    v_mfma_f32_16x16x32_bf16 v[188:191], v[44:47], a[180:183], v[188:191]
    ds_read_b64_tr_b16 v[38:39], v13 offset:26624
    v_mfma_f32_16x16x32_bf16 v[92:95], v[44:47], a[184:187], v[92:95]
    v_mfma_f32_16x16x32_bf16 v[100:103], v[44:47], a[188:191], v[100:103]
    v_mfma_f32_16x16x32_bf16 v[108:111], v[44:47], a[192:195], v[108:111]
    s_waitcnt lgkmcnt(2)
    v_mfma_f32_16x16x32_bf16 v[208:211], v[32:35], a[236:239], v[208:211]
    ds_read_b64_tr_b16 v[40:41], v14 offset:24576
    v_mfma_f32_16x16x32_bf16 v[212:215], v[32:35], a[240:243], v[212:215]
    s_add_u32 s60, s63, 32768
    ds_read_b64_tr_b16 v[42:43], v14 offset:26624
    s_add_u32 m0, s59, 20480
    v_mfma_f32_16x16x32_bf16 v[216:219], v[32:35], a[244:247], v[216:219]
    buffer_load_dwordx4 v4, s[20:23], s60 offen lds
    v_mfma_f32_16x16x32_bf16 v[220:223], v[32:35], a[248:251], v[220:223]
    s_add_u32 m0, s59, 21504
    v_mfma_f32_16x16x32_bf16 v[224:227], v[32:35], a[252:255], v[224:227]
    s_waitcnt lgkmcnt(2)
    buffer_load_dwordx4 v5, s[20:23], s60 offen lds
    v_mfma_f32_16x16x32_bf16 v[228:231], v[36:39], a[236:239], v[228:231]
    ds_read_b64_tr_b16 v[44:45], v15 offset:24576
    v_cvt_pk_bf16_f32 v208, v208, v209
    v_mfma_f32_16x16x32_bf16 v[196:199], v[36:39], a[240:243], v[196:199]
    s_add_u32 m0, s59, 22528
    ds_read_b64_tr_b16 v[46:47], v15 offset:26624
    v_cvt_pk_bf16_f32 v209, v210, v211
    v_mfma_f32_16x16x32_bf16 v[204:207], v[36:39], a[244:247], v[204:207]
    buffer_load_dwordx4 v6, s[20:23], s60 offen lds
    v_cvt_pk_bf16_f32 v210, v212, v213
    v_mfma_f32_16x16x32_bf16 v[52:55], v[36:39], a[248:251], v[52:55]
    s_add_u32 m0, s59, 23552
    v_cvt_pk_bf16_f32 v211, v214, v215
    buffer_store_dwordx4 v[208:211], v29, s[24:27], s73 offen offset:0 sc1
    v_mfma_f32_16x16x32_bf16 v[60:63], v[36:39], a[252:255], v[60:63]
    s_waitcnt vmcnt(20)
    buffer_load_dwordx4 v7, s[20:23], s60 offen lds
    s_barrier
    s_waitcnt lgkmcnt(2)
    v_mfma_f32_16x16x32_bf16 v[68:71], v[40:43], a[236:239], v[68:71]
    ds_read_b64_tr_b16 v[32:33], v8 offset:0
    v_cvt_pk_bf16_f32 v216, v216, v217
    v_mfma_f32_16x16x32_bf16 v[76:79], v[40:43], a[240:243], v[76:79]
    ds_read_b64_tr_b16 v[34:35], v8 offset:2048
    v_cvt_pk_bf16_f32 v217, v218, v219
    v_mfma_f32_16x16x32_bf16 v[84:87], v[40:43], a[244:247], v[84:87]
    v_cvt_pk_bf16_f32 v218, v220, v221
    v_cvt_pk_bf16_f32 v219, v222, v223
    v_mfma_f32_16x16x32_bf16 v[164:167], v[40:43], a[248:251], v[164:167]
    v_readfirstlane_b32 s3, v243
    s_nop 0
    s_cmp_ge_u32 s3, 8
    s_cbranch_scc1 L_rdy_ok
    s_mov_b32 s79, 0
L_rdy:
    buffer_load_dword v243, v250, s[32:35], 0 offen sc1
    s_waitcnt vmcnt(0)
    v_readfirstlane_b32 s3, v243
    s_nop 0
    s_cmp_ge_u32 s3, 8
    s_cbranch_scc1 L_rdy_ok
    s_add_u32 s79, s79, 1
    s_cmp_lt_u32 s79, 0x40000
    s_cbranch_scc1 L_rdy
L_rdy_ok:
    v_mfma_f32_16x16x32_bf16 v[172:175], v[40:43], a[252:255], v[172:175]
    s_waitcnt lgkmcnt(2)
    buffer_store_dwordx4 v[216:219], v29, s[24:27], s73 offen offset:1024 sc1
    v_cvt_pk_bf16_f32 v224, v224, v225
    v_mfma_f32_16x16x32_bf16 v[180:183], v[44:47], a[236:239], v[180:183]
    ds_read_b64_tr_b16 v[36:37], v9 offset:0
    v_cvt_pk_bf16_f32 v225, v226, v227
    v_mfma_f32_16x16x32_bf16 v[188:191], v[44:47], a[240:243], v[188:191]
    ds_read_b64_tr_b16 v[38:39], v9 offset:2048
    v_mfma_f32_16x16x32_bf16 v[92:95], v[44:47], a[244:247], v[92:95]
    buffer_store_dwordx2 v[224:225], v30, s[24:27], s73 offen offset:2048 sc1
    s_add_u32 s73, s73, 2560
    v_cvt_pk_bf16_f32 v228, v228, v229
    v_mfma_f32_16x16x32_bf16 v[100:103], v[44:47], a[248:251], v[100:103]
    v_cvt_pk_bf16_f32 v229, v230, v231
    v_cvt_pk_bf16_f32 v230, v196, v197
    v_mfma_f32_16x16x32_bf16 v[108:111], v[44:47], a[252:255], v[108:111]
    s_waitcnt lgkmcnt(2)
    v_cvt_pk_bf16_f32 v231, v198, v199
    buffer_store_dwordx4 v[228:231], v29, s[24:27], s73 offen offset:0 sc1
    v_mfma_f32_16x16x32_bf16 v[116:119], v[32:35], v[48:51], 0
    ds_read_b64_tr_b16 v[40:41], v10 offset:0
    v_cvt_pk_bf16_f32 v204, v204, v205
    v_mfma_f32_16x16x32_bf16 v[124:127], v[32:35], v[56:59], 0
    ds_read_b64_tr_b16 v[42:43], v10 offset:2048
    v_cvt_pk_bf16_f32 v205, v206, v207
    v_mfma_f32_16x16x32_bf16 v[132:135], v[32:35], v[64:67], 0
    v_cvt_pk_bf16_f32 v206, v52, v53
    v_cvt_pk_bf16_f32 v207, v54, v55
    v_mfma_f32_16x16x32_bf16 v[140:143], v[32:35], v[72:75], 0
    buffer_store_dwordx4 v[204:207], v29, s[24:27], s73 offen offset:1024 sc1
    v_cvt_pk_bf16_f32 v60, v60, v61
    v_mfma_f32_16x16x32_bf16 v[148:151], v[32:35], v[80:83], 0
    s_waitcnt lgkmcnt(2)
    v_cvt_pk_bf16_f32 v61, v62, v63
    buffer_store_dwordx2 v[60:61], v30, s[24:27], s73 offen offset:2048 sc1
    v_mfma_f32_16x16x32_bf16 v[156:159], v[36:39], v[48:51], 0
    s_add_u32 s73, s73, 2560
    ds_read_b64_tr_b16 v[44:45], v11 offset:0
    v_cvt_pk_bf16_f32 v68, v68, v69
    v_mfma_f32_16x16x32_bf16 v[208:211], v[36:39], v[56:59], 0
    ds_read_b64_tr_b16 v[46:47], v11 offset:2048
    v_cvt_pk_bf16_f32 v69, v70, v71
    v_mfma_f32_16x16x32_bf16 v[212:215], v[36:39], v[64:67], 0
    v_cvt_pk_bf16_f32 v70, v76, v77
    v_cvt_pk_bf16_f32 v71, v78, v79
    v_mfma_f32_16x16x32_bf16 v[216:219], v[36:39], v[72:75], 0
    buffer_store_dwordx4 v[68:71], v29, s[24:27], s73 offen offset:0 sc1
    v_cvt_pk_bf16_f32 v84, v84, v85
    v_mfma_f32_16x16x32_bf16 v[220:223], v[36:39], v[80:83], 0
    s_waitcnt vmcnt(23)
    s_barrier
    s_waitcnt lgkmcnt(2)
    v_mfma_f32_16x16x32_bf16 v[116:119], v[40:43], a[16:19], v[116:119]
    ds_read_b64_tr_b16 v[32:33], v8 offset:4096
    v_cvt_pk_bf16_f32 v85, v86, v87
    v_mfma_f32_16x16x32_bf16 v[124:127], v[40:43], a[20:23], v[124:127]
    ds_read_b64_tr_b16 v[34:35], v8 offset:6144
    v_cvt_pk_bf16_f32 v86, v164, v165
    v_mfma_f32_16x16x32_bf16 v[132:135], v[40:43], a[24:27], v[132:135]
    v_cvt_pk_bf16_f32 v87, v166, v167
    buffer_store_dwordx4 v[84:87], v29, s[24:27], s73 offen offset:1024 sc1
    v_mfma_f32_16x16x32_bf16 v[140:143], v[40:43], a[28:31], v[140:143]
    v_cvt_pk_bf16_f32 v172, v172, v173
    v_cvt_pk_bf16_f32 v173, v174, v175
    v_mfma_f32_16x16x32_bf16 v[148:151], v[40:43], a[32:35], v[148:151]
    s_waitcnt lgkmcnt(2)
    buffer_store_dwordx2 v[172:173], v30, s[24:27], s73 offen offset:2048 sc1
    s_add_u32 s73, s73, 2560
    v_mfma_f32_16x16x32_bf16 v[156:159], v[44:47], a[16:19], v[156:159]
    ds_read_b64_tr_b16 v[36:37], v9 offset:4096
    v_cvt_pk_bf16_f32 v180, v180, v181
    v_mfma_f32_16x16x32_bf16 v[208:211], v[44:47], a[20:23], v[208:211]
    ds_read_b64_tr_b16 v[38:39], v9 offset:6144
    v_cvt_pk_bf16_f32 v181, v182, v183
    v_mfma_f32_16x16x32_bf16 v[212:215], v[44:47], a[24:27], v[212:215]
    v_cvt_pk_bf16_f32 v182, v188, v189
    v_cvt_pk_bf16_f32 v183, v190, v191
    v_mfma_f32_16x16x32_bf16 v[216:219], v[44:47], a[28:31], v[216:219]
    buffer_store_dwordx4 v[180:183], v29, s[24:27], s73 offen offset:0 sc1
    v_cvt_pk_bf16_f32 v92, v92, v93
    v_mfma_f32_16x16x32_bf16 v[220:223], v[44:47], a[32:35], v[220:223]
    s_waitcnt lgkmcnt(2)
    v_cvt_pk_bf16_f32 v93, v94, v95
    v_cvt_pk_bf16_f32 v94, v100, v101
    v_mfma_f32_16x16x32_bf16 v[116:119], v[32:35], v[88:91], v[116:119]
    ds_read_b64_tr_b16 v[40:41], v10 offset:4096
    v_cvt_pk_bf16_f32 v95, v102, v103
    v_mfma_f32_16x16x32_bf16 v[124:127], v[32:35], v[96:99], v[124:127]
    ds_read_b64_tr_b16 v[42:43], v10 offset:6144
    v_mfma_f32_16x16x32_bf16 v[132:135], v[32:35], v[104:107], v[132:135]
    buffer_store_dwordx4 v[92:95], v29, s[24:27], s73 offen offset:1024 sc1
    v_cvt_pk_bf16_f32 v108, v108, v109
    v_mfma_f32_16x16x32_bf16 v[140:143], v[32:35], v[112:115], v[140:143]
    v_cvt_pk_bf16_f32 v109, v110, v111
    buffer_store_dwordx2 v[108:109], v30, s[24:27], s73 offen offset:2048 sc1
    v_mfma_f32_16x16x32_bf16 v[148:151], v[32:35], v[120:123], v[148:151]
    s_waitcnt lgkmcnt(2)
    v_mfma_f32_16x16x32_bf16 v[156:159], v[36:39], v[88:91], v[156:159]
    ds_read_b64_tr_b16 v[44:45], v11 offset:4096
    v_mfma_f32_16x16x32_bf16 v[208:211], v[36:39], v[96:99], v[208:211]
    ds_read_b64_tr_b16 v[46:47], v11 offset:6144
    v_mfma_f32_16x16x32_bf16 v[212:215], v[36:39], v[104:107], v[212:215]
    v_mfma_f32_16x16x32_bf16 v[216:219], v[36:39], v[112:115], v[216:219]
    v_mfma_f32_16x16x32_bf16 v[220:223], v[36:39], v[120:123], v[220:223]
    s_waitcnt vmcnt(24)
    s_barrier
    s_waitcnt lgkmcnt(2)
    v_mfma_f32_16x16x32_bf16 v[116:119], v[40:43], a[76:79], v[116:119]
    ds_read_b64_tr_b16 v[32:33], v8 offset:8192
    v_mfma_f32_16x16x32_bf16 v[124:127], v[40:43], a[80:83], v[124:127]
    ds_read_b64_tr_b16 v[34:35], v8 offset:10240
    v_mfma_f32_16x16x32_bf16 v[132:135], v[40:43], a[84:87], v[132:135]
    v_mfma_f32_16x16x32_bf16 v[140:143], v[40:43], a[88:91], v[140:143]
    v_mfma_f32_16x16x32_bf16 v[148:151], v[40:43], a[92:95], v[148:151]
    s_waitcnt lgkmcnt(2)
    v_mfma_f32_16x16x32_bf16 v[156:159], v[44:47], a[76:79], v[156:159]
    ds_read_b64_tr_b16 v[36:37], v9 offset:8192
    v_mfma_f32_16x16x32_bf16 v[208:211], v[44:47], a[80:83], v[208:211]
    ds_read_b64_tr_b16 v[38:39], v9 offset:10240
    v_mfma_f32_16x16x32_bf16 v[212:215], v[44:47], a[84:87], v[212:215]
    v_mfma_f32_16x16x32_bf16 v[216:219], v[44:47], a[88:91], v[216:219]
    v_mfma_f32_16x16x32_bf16 v[220:223], v[44:47], a[92:95], v[220:223]
    s_waitcnt lgkmcnt(2)
    v_mfma_f32_16x16x32_bf16 v[116:119], v[32:35], v[128:131], v[116:119]
    ds_read_b64_tr_b16 v[40:41], v10 offset:8192
    v_mfma_f32_16x16x32_bf16 v[124:127], v[32:35], v[136:139], v[124:127]
    ds_read_b64_tr_b16 v[42:43], v10 offset:10240
    v_mfma_f32_16x16x32_bf16 v[132:135], v[32:35], v[144:147], v[132:135]
    v_mfma_f32_16x16x32_bf16 v[140:143], v[32:35], v[152:155], v[140:143]
    v_mfma_f32_16x16x32_bf16 v[148:151], v[32:35], v[160:163], v[148:151]
    s_waitcnt lgkmcnt(2)
    v_mfma_f32_16x16x32_bf16 v[156:159], v[36:39], v[128:131], v[156:159]
    ds_read_b64_tr_b16 v[44:45], v11 offset:8192
    v_mfma_f32_16x16x32_bf16 v[208:211], v[36:39], v[136:139], v[208:211]
    ds_read_b64_tr_b16 v[46:47], v11 offset:10240
    v_mfma_f32_16x16x32_bf16 v[212:215], v[36:39], v[144:147], v[212:215]
    v_mfma_f32_16x16x32_bf16 v[216:219], v[36:39], v[152:155], v[216:219]
    v_mfma_f32_16x16x32_bf16 v[220:223], v[36:39], v[160:163], v[220:223]
    s_waitcnt vmcnt(20)
    s_barrier
    s_waitcnt lgkmcnt(2)
    v_mfma_f32_16x16x32_bf16 v[116:119], v[40:43], a[136:139], v[116:119]
    ds_read_b64_tr_b16 v[32:33], v8 offset:12288
    v_mfma_f32_16x16x32_bf16 v[124:127], v[40:43], a[140:143], v[124:127]
    ds_read_b64_tr_b16 v[34:35], v8 offset:14336
    v_mfma_f32_16x16x32_bf16 v[132:135], v[40:43], a[144:147], v[132:135]
    v_mfma_f32_16x16x32_bf16 v[140:143], v[40:43], a[148:151], v[140:143]
    v_mfma_f32_16x16x32_bf16 v[148:151], v[40:43], a[152:155], v[148:151]
    s_waitcnt lgkmcnt(2)
    v_mfma_f32_16x16x32_bf16 v[156:159], v[44:47], a[136:139], v[156:159]
    ds_read_b64_tr_b16 v[36:37], v9 offset:12288
    v_mfma_f32_16x16x32_bf16 v[208:211], v[44:47], a[140:143], v[208:211]
    ds_read_b64_tr_b16 v[38:39], v9 offset:14336
    v_mfma_f32_16x16x32_bf16 v[212:215], v[44:47], a[144:147], v[212:215]
    v_mfma_f32_16x16x32_bf16 v[216:219], v[44:47], a[148:151], v[216:219]
    v_mfma_f32_16x16x32_bf16 v[220:223], v[44:47], a[152:155], v[220:223]
    s_waitcnt lgkmcnt(2)
    v_mfma_f32_16x16x32_bf16 v[116:119], v[32:35], v[168:171], v[116:119]
    ds_read_b64_tr_b16 v[40:41], v10 offset:12288
    v_mfma_f32_16x16x32_bf16 v[124:127], v[32:35], v[176:179], v[124:127]
    ds_read_b64_tr_b16 v[42:43], v10 offset:14336
    v_mfma_f32_16x16x32_bf16 v[132:135], v[32:35], v[184:187], v[132:135]
    v_mfma_f32_16x16x32_bf16 v[140:143], v[32:35], v[192:195], v[140:143]
    s_waitcnt vmcnt(0)
    s_mov_b64 exec, 15
    buffer_store_dword v249, v248, s[24:27], s74 offen sc1
    s_mov_b64 exec, -1
    v_mfma_f32_16x16x32_bf16 v[148:151], v[32:35], v[200:203], v[148:151]
    s_waitcnt lgkmcnt(2)
    v_mfma_f32_16x16x32_bf16 v[156:159], v[36:39], v[168:171], v[156:159]
    ds_read_b64_tr_b16 v[44:45], v11 offset:12288
    v_mfma_f32_16x16x32_bf16 v[208:211], v[36:39], v[176:179], v[208:211]
    ds_read_b64_tr_b16 v[46:47], v11 offset:14336
    v_mfma_f32_16x16x32_bf16 v[212:215], v[36:39], v[184:187], v[212:215]
    v_mfma_f32_16x16x32_bf16 v[216:219], v[36:39], v[192:195], v[216:219]
    v_mfma_f32_16x16x32_bf16 v[220:223], v[36:39], v[200:203], v[220:223]
    s_barrier
    s_waitcnt lgkmcnt(2)
    v_mfma_f32_16x16x32_bf16 v[116:119], v[40:43], a[196:199], v[116:119]
    ds_read_b64_tr_b16 v[32:33], v8 offset:16384
    v_mfma_f32_16x16x32_bf16 v[124:127], v[40:43], a[200:203], v[124:127]
    s_add_u32 s60, s63, 65536
    ds_read_b64_tr_b16 v[34:35], v8 offset:18432
    s_add_u32 m0, s59, 28672
    v_mfma_f32_16x16x32_bf16 v[132:135], v[40:43], a[204:207], v[132:135]
    buffer_load_dwordx4 v4, s[20:23], s60 offen lds
    v_mfma_f32_16x16x32_bf16 v[140:143], v[40:43], a[208:211], v[140:143]
    s_add_u32 m0, s59, 29696
    v_mfma_f32_16x16x32_bf16 v[148:151], v[40:43], a[212:215], v[148:151]
    s_waitcnt lgkmcnt(2)
    buffer_load_dwordx4 v5, s[20:23], s60 offen lds
    v_mfma_f32_16x16x32_bf16 v[156:159], v[44:47], a[196:199], v[156:159]
    ds_read_b64_tr_b16 v[36:37], v9 offset:16384
    v_mfma_f32_16x16x32_bf16 v[208:211], v[44:47], a[200:203], v[208:211]
    s_add_u32 m0, s59, 30720
    ds_read_b64_tr_b16 v[38:39], v9 offset:18432
    v_mfma_f32_16x16x32_bf16 v[212:215], v[44:47], a[204:207], v[212:215]
    buffer_load_dwordx4 v6, s[20:23], s60 offen lds
    v_mfma_f32_16x16x32_bf16 v[216:219], v[44:47], a[208:211], v[216:219]
    s_add_u32 m0, s59, 31744
    v_mfma_f32_16x16x32_bf16 v[220:223], v[44:47], a[212:215], v[220:223]
    s_waitcnt lgkmcnt(2)
    buffer_load_dwordx4 v7, s[20:23], s60 offen lds
    v_mfma_f32_16x16x32_bf16 v[116:119], v[32:35], a[36:39], v[116:119]
    ds_read_b64_tr_b16 v[40:41], v10 offset:16384
    v_mfma_f32_16x16x32_bf16 v[124:127], v[32:35], a[40:43], v[124:127]
    ds_read_b64_tr_b16 v[42:43], v10 offset:18432
    v_mfma_f32_16x16x32_bf16 v[132:135], v[32:35], a[44:47], v[132:135]
    v_mfma_f32_16x16x32_bf16 v[140:143], v[32:35], a[48:51], v[140:143]
    s_add_u32 s60, s63, 98304
    s_add_u32 m0, s59, 32768
    v_mfma_f32_16x16x32_bf16 v[148:151], v[32:35], a[52:55], v[148:151]
    s_waitcnt lgkmcnt(2)
    buffer_load_dwordx4 v4, s[20:23], s60 offen lds
    s_lshr_b32 s96, s54, 2
    v_mfma_f32_16x16x32_bf16 v[156:159], v[36:39], a[36:39], v[156:159]
    s_add_u32 s96, s96, s56
    ds_read_b64_tr_b16 v[44:45], v11 offset:16384
    s_add_u32 s96, s96, 7
    v_mfma_f32_16x16x32_bf16 v[208:211], v[36:39], a[40:43], v[208:211]
    s_add_u32 m0, s59, 33792
    ds_read_b64_tr_b16 v[46:47], v11 offset:18432
    s_and_b32 s96, s96, 7
    v_mfma_f32_16x16x32_bf16 v[212:215], v[36:39], a[44:47], v[212:215]
    s_lshl_b32 s96, s96, 7
    buffer_load_dwordx4 v5, s[20:23], s60 offen lds
    s_xor_b32 s61, s54, 0
    v_mfma_f32_16x16x32_bf16 v[216:219], v[36:39], a[48:51], v[216:219]
    s_add_u32 m0, s59, 34816
    s_lshl_b32 s61, s61, 17
    s_add_u32 s61, s61, s96
    v_mfma_f32_16x16x32_bf16 v[220:223], v[36:39], a[52:55], v[220:223]
    buffer_load_dwordx4 v6, s[20:23], s60 offen lds
    s_barrier
    s_waitcnt lgkmcnt(2)
    v_mfma_f32_16x16x32_bf16 v[116:119], v[40:43], a[56:59], v[116:119]
    s_xor_b32 s100, s54, 0
    ds_read_b64_tr_b16 v[32:33], v8 offset:20480
    v_mfma_f32_16x16x32_bf16 v[124:127], v[40:43], a[60:63], v[124:127]
    s_add_u32 m0, s59, 35840
    ds_read_b64_tr_b16 v[34:35], v8 offset:22528
    v_mfma_f32_16x16x32_bf16 v[132:135], v[40:43], a[64:67], v[132:135]
    s_mul_i32 s100, s100, 40960
    buffer_load_dwordx4 v7, s[20:23], s60 offen lds
    v_mfma_f32_16x16x32_bf16 v[140:143], v[40:43], a[68:71], v[140:143]
    s_lshl_b32 s101, s54, 5
    v_xor_b32 v12, s101, v31
    v_add_u32 v12, s100, v12
    v_mfma_f32_16x16x32_bf16 v[148:151], v[40:43], a[72:75], v[148:151]
    s_waitcnt lgkmcnt(2)
    v_mfma_f32_16x16x32_bf16 v[156:159], v[44:47], a[56:59], v[156:159]
    s_xor_b32 s100, s54, 1
    ds_read_b64_tr_b16 v[36:37], v9 offset:20480
    v_mfma_f32_16x16x32_bf16 v[208:211], v[44:47], a[60:63], v[208:211]
    s_mul_i32 s100, s100, 40960
    ds_read_b64_tr_b16 v[38:39], v9 offset:22528
    v_xor_b32 v13, s101, v31
    v_mfma_f32_16x16x32_bf16 v[212:215], v[44:47], a[64:67], v[212:215]
    s_add_u32 s60, s61, 0
    s_add_u32 m0, s59, 36864
    v_add_u32 v13, s100, v13
    v_mfma_f32_16x16x32_bf16 v[216:219], v[44:47], a[68:71], v[216:219]
    s_xor_b32 s100, s54, 2
    buffer_load_dwordx4 v4, s[20:23], s60 offen lds
    v_mfma_f32_16x16x32_bf16 v[220:223], v[44:47], a[72:75], v[220:223]
    s_waitcnt lgkmcnt(2)
    v_mfma_f32_16x16x32_bf16 v[116:119], v[32:35], a[96:99], v[116:119]
    s_mul_i32 s100, s100, 40960
    ds_read_b64_tr_b16 v[40:41], v10 offset:20480
    v_xor_b32 v14, s101, v31
    v_mfma_f32_16x16x32_bf16 v[124:127], v[32:35], a[100:103], v[124:127]
    s_add_u32 m0, s59, 37888
    ds_read_b64_tr_b16 v[42:43], v10 offset:22528
    v_add_u32 v14, s100, v14
    v_mfma_f32_16x16x32_bf16 v[132:135], v[32:35], a[104:107], v[132:135]
    s_xor_b32 s100, s54, 3
    buffer_load_dwordx4 v5, s[20:23], s60 offen lds
    v_mfma_f32_16x16x32_bf16 v[140:143], v[32:35], a[108:111], v[140:143]
    s_add_u32 m0, s59, 38912
    v_mfma_f32_16x16x32_bf16 v[148:151], v[32:35], a[112:115], v[148:151]
    s_waitcnt lgkmcnt(2)
    buffer_load_dwordx4 v6, s[20:23], s60 offen lds
    v_mfma_f32_16x16x32_bf16 v[156:159], v[36:39], a[96:99], v[156:159]
    s_mul_i32 s100, s100, 40960
    ds_read_b64_tr_b16 v[44:45], v11 offset:20480
    v_xor_b32 v15, s101, v31
    v_mfma_f32_16x16x32_bf16 v[208:211], v[36:39], a[100:103], v[208:211]
    s_add_u32 m0, s59, 39936
    ds_read_b64_tr_b16 v[46:47], v11 offset:22528
    v_add_u32 v15, s100, v15
    v_mfma_f32_16x16x32_bf16 v[212:215], v[36:39], a[104:107], v[212:215]
    buffer_load_dwordx4 v7, s[20:23], s60 offen lds
    v_mfma_f32_16x16x32_bf16 v[216:219], v[36:39], a[108:111], v[216:219]
    v_mfma_f32_16x16x32_bf16 v[220:223], v[36:39], a[112:115], v[220:223]
    s_waitcnt vmcnt(8)
    s_barrier
    s_waitcnt lgkmcnt(2)
    v_mfma_f32_16x16x32_bf16 v[116:119], v[40:43], a[116:119], v[116:119]
    ds_read_b64_tr_b16 v[32:33], v8 offset:28672
    v_mfma_f32_16x16x32_bf16 v[124:127], v[40:43], a[120:123], v[124:127]
    s_add_u32 s60, s61, 32768
    ds_read_b64_tr_b16 v[34:35], v8 offset:30720
    s_add_u32 m0, s59, 24576
    v_mfma_f32_16x16x32_bf16 v[132:135], v[40:43], a[124:127], v[132:135]
    buffer_load_dwordx4 v4, s[20:23], s60 offen lds
    v_mfma_f32_16x16x32_bf16 v[140:143], v[40:43], a[128:131], v[140:143]
    s_add_u32 m0, s59, 25600
    v_mfma_f32_16x16x32_bf16 v[148:151], v[40:43], a[132:135], v[148:151]
    s_waitcnt lgkmcnt(2)
    buffer_load_dwordx4 v5, s[20:23], s60 offen lds
    v_mfma_f32_16x16x32_bf16 v[156:159], v[44:47], a[116:119], v[156:159]
    ds_read_b64_tr_b16 v[36:37], v9 offset:28672
    v_mfma_f32_16x16x32_bf16 v[208:211], v[44:47], a[120:123], v[208:211]
    s_add_u32 m0, s59, 26624
    ds_read_b64_tr_b16 v[38:39], v9 offset:30720
    v_mfma_f32_16x16x32_bf16 v[212:215], v[44:47], a[124:127], v[212:215]
    buffer_load_dwordx4 v6, s[20:23], s60 offen lds
    v_mfma_f32_16x16x32_bf16 v[216:219], v[44:47], a[128:131], v[216:219]
    s_add_u32 m0, s59, 27648
    v_mfma_f32_16x16x32_bf16 v[220:223], v[44:47], a[132:135], v[220:223]
    s_waitcnt lgkmcnt(2)
    buffer_load_dwordx4 v7, s[20:23], s60 offen lds
    v_mfma_f32_16x16x32_bf16 v[116:119], v[32:35], a[156:159], v[116:119]
    ds_read_b64_tr_b16 v[40:41], v10 offset:28672
    v_mfma_f32_16x16x32_bf16 v[124:127], v[32:35], a[160:163], v[124:127]
    ds_read_b64_tr_b16 v[42:43], v10 offset:30720
    v_mfma_f32_16x16x32_bf16 v[132:135], v[32:35], a[164:167], v[132:135]
    v_mfma_f32_16x16x32_bf16 v[140:143], v[32:35], a[168:171], v[140:143]
    v_mfma_f32_16x16x32_bf16 v[148:151], v[32:35], a[172:175], v[148:151]
    s_waitcnt lgkmcnt(2)
    v_mfma_f32_16x16x32_bf16 v[156:159], v[36:39], a[156:159], v[156:159]
    ds_read_b64_tr_b16 v[44:45], v11 offset:28672
    v_mfma_f32_16x16x32_bf16 v[208:211], v[36:39], a[160:163], v[208:211]
    s_add_u32 s60, s61, 65536
    ds_read_b64_tr_b16 v[46:47], v11 offset:30720
    s_add_u32 m0, s59, 0
    v_mfma_f32_16x16x32_bf16 v[212:215], v[36:39], a[164:167], v[212:215]
    s_lshr_b32 s97, s54, 1
    buffer_load_dwordx4 v4, s[20:23], s60 offen lds
    s_add_u32 s97, s97, 5
    v_mfma_f32_16x16x32_bf16 v[216:219], v[36:39], a[168:171], v[216:219]
    s_add_u32 m0, s59, 1024
    s_add_u32 s98, s97, s56
    s_and_b32 s98, s98, 7
    v_mfma_f32_16x16x32_bf16 v[220:223], v[36:39], a[172:175], v[220:223]
    s_waitcnt vmcnt(9)
    buffer_load_dwordx4 v5, s[20:23], s60 offen lds
    s_barrier
    s_waitcnt lgkmcnt(2)
    v_mfma_f32_16x16x32_bf16 v[116:119], v[40:43], a[176:179], v[116:119]
    s_lshl_b32 s99, s58, 3
    ds_read_b64_tr_b16 v[32:33], v8 offset:32768
    s_add_u32 s98, s98, s99
    v_mfma_f32_16x16x32_bf16 v[124:127], v[40:43], a[180:183], v[124:127]
    s_add_u32 m0, s59, 2048
    ds_read_b64_tr_b16 v[34:35], v8 offset:34816
    s_lshl_b32 s73, s98, 3
    v_mfma_f32_16x16x32_bf16 v[132:135], v[40:43], a[184:187], v[132:135]
    s_add_u32 s73, s73, s97
    buffer_load_dwordx4 v6, s[20:23], s60 offen lds
    s_mul_i32 s73, s73, 10240
    v_mfma_f32_16x16x32_bf16 v[140:143], v[40:43], a[188:191], v[140:143]
    s_add_u32 m0, s59, 3072
    s_lshl_b32 s98, s98, 7
    s_lshl_b32 s97, s97, 2
    v_mfma_f32_16x16x32_bf16 v[148:151], v[40:43], a[192:195], v[148:151]
    s_waitcnt lgkmcnt(2)
    buffer_load_dwordx4 v7, s[20:23], s60 offen lds
    s_add_u32 s98, s98, s97
    v_mfma_f32_16x16x32_bf16 v[156:159], v[44:47], a[176:179], v[156:159]
    s_add_u32 s74, s98, 33554432
    ds_read_b64_tr_b16 v[36:37], v9 offset:32768
    s_and_b32 s97, s54, 1
    v_mfma_f32_16x16x32_bf16 v[208:211], v[44:47], a[180:183], v[208:211]
    s_mul_i32 s99, s97, 5120
    ds_read_b64_tr_b16 v[38:39], v9 offset:34816
    s_add_u32 s73, s73, s99
    v_mfma_f32_16x16x32_bf16 v[212:215], v[44:47], a[184:187], v[212:215]
    s_lshl_b32 s99, s97, 6
    s_add_u32 s74, s74, s99
    v_mfma_f32_16x16x32_bf16 v[216:219], v[44:47], a[188:191], v[216:219]
    v_mfma_f32_16x16x32_bf16 v[220:223], v[44:47], a[192:195], v[220:223]
    s_waitcnt lgkmcnt(2)
    v_mfma_f32_16x16x32_bf16 v[116:119], v[32:35], a[216:219], v[116:119]
    ds_read_b64_tr_b16 v[40:41], v10 offset:32768
    v_mfma_f32_16x16x32_bf16 v[124:127], v[32:35], a[220:223], v[124:127]
    s_add_u32 s60, s61, 98304
    ds_read_b64_tr_b16 v[42:43], v10 offset:34816
    s_add_u32 m0, s59, 4096
    v_mfma_f32_16x16x32_bf16 v[132:135], v[32:35], a[224:227], v[132:135]
    s_lshr_b32 s96, s54, 2
    buffer_load_dwordx4 v4, s[20:23], s60 offen lds
    s_add_u32 s96, s96, s56
    v_mfma_f32_16x16x32_bf16 v[140:143], v[32:35], a[228:231], v[140:143]
    s_add_u32 m0, s59, 5120
    s_add_u32 s96, s96, 8
    s_and_b32 s96, s96, 7
    v_mfma_f32_16x16x32_bf16 v[148:151], v[32:35], a[232:235], v[148:151]
    s_waitcnt lgkmcnt(2)
    buffer_load_dwordx4 v5, s[20:23], s60 offen lds
    s_lshl_b32 s96, s96, 7
    v_mfma_f32_16x16x32_bf16 v[156:159], v[36:39], a[216:219], v[156:159]
    s_xor_b32 s61, s54, 0
    ds_read_b64_tr_b16 v[44:45], v11 offset:32768
    s_lshl_b32 s61, s61, 17
    v_mfma_f32_16x16x32_bf16 v[208:211], v[36:39], a[220:223], v[208:211]
    s_add_u32 m0, s59, 6144
    ds_read_b64_tr_b16 v[46:47], v11 offset:34816
    s_add_u32 s61, s61, s96
    v_mfma_f32_16x16x32_bf16 v[212:215], v[36:39], a[224:227], v[212:215]
    buffer_load_dwordx4 v6, s[20:23], s60 offen lds
    v_mfma_f32_16x16x32_bf16 v[216:219], v[36:39], a[228:231], v[216:219]
    s_add_u32 m0, s59, 7168
    v_mfma_f32_16x16x32_bf16 v[220:223], v[36:39], a[232:235], v[220:223]
    s_waitcnt vmcnt(11)
    buffer_load_dwordx4 v7, s[20:23], s60 offen lds
    s_barrier
    s_waitcnt lgkmcnt(2)
    v_mfma_f32_16x16x32_bf16 v[116:119], v[40:43], a[236:239], v[116:119]
    ds_read_b64_tr_b16 v[32:33], v12 offset:36864
    v_mfma_f32_16x16x32_bf16 v[124:127], v[40:43], a[240:243], v[124:127]
    ds_read_b64_tr_b16 v[34:35], v12 offset:38912
    v_mfma_f32_16x16x32_bf16 v[132:135], v[40:43], a[244:247], v[132:135]
    v_mfma_f32_16x16x32_bf16 v[140:143], v[40:43], a[248:251], v[140:143]
    s_add_u32 s60, s61, 0
    s_add_u32 m0, s59, 8192
    v_mfma_f32_16x16x32_bf16 v[148:151], v[40:43], a[252:255], v[148:151]
    s_waitcnt lgkmcnt(2)
    buffer_load_dwordx4 v4, s[20:23], s60 offen lds
    v_mfma_f32_16x16x32_bf16 v[156:159], v[44:47], a[236:239], v[156:159]
    ds_read_b64_tr_b16 v[36:37], v13 offset:36864
    v_cvt_pk_bf16_f32 v116, v116, v117
    v_mfma_f32_16x16x32_bf16 v[208:211], v[44:47], a[240:243], v[208:211]
    s_add_u32 m0, s59, 9216
    ds_read_b64_tr_b16 v[38:39], v13 offset:38912
    v_cvt_pk_bf16_f32 v117, v118, v119
    v_mfma_f32_16x16x32_bf16 v[212:215], v[44:47], a[244:247], v[212:215]
    buffer_load_dwordx4 v5, s[20:23], s60 offen lds
    v_cvt_pk_bf16_f32 v118, v124, v125
    v_mfma_f32_16x16x32_bf16 v[216:219], v[44:47], a[248:251], v[216:219]
    s_add_u32 m0, s59, 10240
    v_cvt_pk_bf16_f32 v119, v126, v127
    buffer_store_dwordx4 v[116:119], v29, s[24:27], s73 offen offset:0 sc1
    v_mfma_f32_16x16x32_bf16 v[220:223], v[44:47], a[252:255], v[220:223]
    s_waitcnt lgkmcnt(2)
    buffer_load_dwordx4 v6, s[20:23], s60 offen lds
    v_cvt_pk_bf16_f32 v132, v132, v133
    v_mfma_f32_16x16x32_bf16 v[224:227], v[32:35], v[48:51], 0
    ds_read_b64_tr_b16 v[40:41], v14 offset:36864
    v_cvt_pk_bf16_f32 v133, v134, v135
    v_mfma_f32_16x16x32_bf16 v[228:231], v[32:35], v[56:59], 0
    s_add_u32 m0, s59, 11264
    ds_read_b64_tr_b16 v[42:43], v14 offset:38912
    v_cvt_pk_bf16_f32 v134, v140, v141
    v_mfma_f32_16x16x32_bf16 v[196:199], v[32:35], v[64:67], 0
    buffer_load_dwordx4 v7, s[20:23], s60 offen lds
    v_cvt_pk_bf16_f32 v135, v142, v143
    v_mfma_f32_16x16x32_bf16 v[204:207], v[32:35], v[72:75], 0
    buffer_store_dwordx4 v[132:135], v29, s[24:27], s73 offen offset:1024 sc1
    v_cvt_pk_bf16_f32 v148, v148, v149
    v_mfma_f32_16x16x32_bf16 v[52:55], v[32:35], v[80:83], 0
    s_waitcnt lgkmcnt(2)
    v_cvt_pk_bf16_f32 v149, v150, v151
    buffer_store_dwordx2 v[148:149], v30, s[24:27], s73 offen offset:2048 sc1
    v_mfma_f32_16x16x32_bf16 v[224:227], v[36:39], a[16:19], v[224:227]
    s_add_u32 s73, s73, 2560
    ds_read_b64_tr_b16 v[44:45], v15 offset:36864
    v_cvt_pk_bf16_f32 v156, v156, v157
    v_mfma_f32_16x16x32_bf16 v[228:231], v[36:39], a[20:23], v[228:231]
    ds_read_b64_tr_b16 v[46:47], v15 offset:38912
    v_cvt_pk_bf16_f32 v157, v158, v159
    v_mfma_f32_16x16x32_bf16 v[196:199], v[36:39], a[24:27], v[196:199]
    s_add_u32 s60, s61, 32768
    s_add_u32 m0, s59, 12288
    v_cvt_pk_bf16_f32 v158, v208, v209
    v_mfma_f32_16x16x32_bf16 v[204:207], v[36:39], a[28:31], v[204:207]
    buffer_load_dwordx4 v4, s[20:23], s60 offen lds
    v_cvt_pk_bf16_f32 v159, v210, v211
    v_mfma_f32_16x16x32_bf16 v[52:55], v[36:39], a[32:35], v[52:55]
    s_waitcnt vmcnt(16)
    s_barrier
    s_waitcnt lgkmcnt(2)
    v_mfma_f32_16x16x32_bf16 v[224:227], v[40:43], a[36:39], v[224:227]
    s_xor_b32 s100, s54, 0
    ds_read_b64_tr_b16 v[32:33], v12 offset:24576
    v_mfma_f32_16x16x32_bf16 v[228:231], v[40:43], a[40:43], v[228:231]
    s_add_u32 m0, s59, 13312
    ds_read_b64_tr_b16 v[34:35], v12 offset:26624
    v_mfma_f32_16x16x32_bf16 v[196:199], v[40:43], a[44:47], v[196:199]
    s_mul_i32 s100, s100, 40960
    buffer_load_dwordx4 v5, s[20:23], s60 offen lds
    v_mfma_f32_16x16x32_bf16 v[204:207], v[40:43], a[48:51], v[204:207]
    s_add_u32 m0, s59, 14336
    buffer_store_dwordx4 v[156:159], v29, s[24:27], s73 offen offset:0 sc1
    v_cvt_pk_bf16_f32 v212, v212, v213
    v_mfma_f32_16x16x32_bf16 v[52:55], v[40:43], a[52:55], v[52:55]
    s_waitcnt lgkmcnt(2)
    buffer_load_dwordx4 v6, s[20:23], s60 offen lds
    v_cvt_pk_bf16_f32 v213, v214, v215
    v_mfma_f32_16x16x32_bf16 v[224:227], v[44:47], a[56:59], v[224:227]
    s_lshl_b32 s101, s54, 5
    ds_read_b64_tr_b16 v[36:37], v13 offset:24576
    v_xor_b32 v8, s101, v31
    v_mfma_f32_16x16x32_bf16 v[228:231], v[44:47], a[60:63], v[228:231]
    s_add_u32 m0, s59, 15360
    ds_read_b64_tr_b16 v[38:39], v13 offset:26624
    v_add_u32 v8, s100, v8
    v_mfma_f32_16x16x32_bf16 v[196:199], v[44:47], a[64:67], v[196:199]
    s_xor_b32 s100, s54, 1
    buffer_load_dwordx4 v7, s[20:23], s60 offen lds
    v_cvt_pk_bf16_f32 v214, v216, v217
    v_mfma_f32_16x16x32_bf16 v[204:207], v[44:47], a[68:71], v[204:207]
    s_mul_i32 s100, s100, 40960
    v_xor_b32 v9, s101, v31
    v_add_u32 v9, s100, v9
    v_mfma_f32_16x16x32_bf16 v[52:55], v[44:47], a[72:75], v[52:55]
    s_waitcnt lgkmcnt(2)
    v_cvt_pk_bf16_f32 v215, v218, v219
    buffer_store_dwordx4 v[212:215], v29, s[24:27], s73 offen offset:1024 sc1
    v_mfma_f32_16x16x32_bf16 v[224:227], v[32:35], v[88:91], v[224:227]
    s_xor_b32 s100, s54, 2
    ds_read_b64_tr_b16 v[40:41], v14 offset:24576
    v_cvt_pk_bf16_f32 v220, v220, v221
    v_mfma_f32_16x16x32_bf16 v[228:231], v[32:35], v[96:99], v[228:231]
    s_add_u32 s60, s61, 65536
    ds_read_b64_tr_b16 v[42:43], v14 offset:26624
    s_add_u32 m0, s59, 16384
    v_mfma_f32_16x16x32_bf16 v[196:199], v[32:35], v[104:107], v[196:199]
    s_mul_i32 s100, s100, 40960
    buffer_load_dwordx4 v4, s[20:23], s60 offen lds
    v_xor_b32 v10, s101, v31
    v_mfma_f32_16x16x32_bf16 v[204:207], v[32:35], v[112:115], v[204:207]
    s_add_u32 m0, s59, 17408
    v_add_u32 v10, s100, v10
    v_cvt_pk_bf16_f32 v221, v222, v223
    v_mfma_f32_16x16x32_bf16 v[52:55], v[32:35], v[120:123], v[52:55]
    s_waitcnt lgkmcnt(2)
    buffer_load_dwordx4 v5, s[20:23], s60 offen lds
    v_mfma_f32_16x16x32_bf16 v[224:227], v[36:39], a[76:79], v[224:227]
    s_xor_b32 s100, s54, 3
    ds_read_b64_tr_b16 v[44:45], v15 offset:24576
    v_mfma_f32_16x16x32_bf16 v[228:231], v[36:39], a[80:83], v[228:231]
    s_add_u32 m0, s59, 18432
    ds_read_b64_tr_b16 v[46:47], v15 offset:26624
    v_mfma_f32_16x16x32_bf16 v[196:199], v[36:39], a[84:87], v[196:199]
    s_mul_i32 s100, s100, 40960
    buffer_load_dwordx4 v6, s[20:23], s60 offen lds
    v_xor_b32 v11, s101, v31
    v_mfma_f32_16x16x32_bf16 v[204:207], v[36:39], a[88:91], v[204:207]
    s_add_u32 m0, s59, 19456
    buffer_store_dwordx2 v[220:221], v30, s[24:27], s73 offen offset:2048 sc1
    v_add_u32 v11, s100, v11
    v_mfma_f32_16x16x32_bf16 v[52:55], v[36:39], a[92:95], v[52:55]
    s_waitcnt vmcnt(21)
    buffer_load_dwordx4 v7, s[20:23], s60 offen lds
    s_barrier
    s_waitcnt lgkmcnt(2)
    v_mfma_f32_16x16x32_bf16 v[224:227], v[40:43], a[96:99], v[224:227]
    ds_read_b64_tr_b16 v[32:33], v12 offset:0
    v_mfma_f32_16x16x32_bf16 v[228:231], v[40:43], a[100:103], v[228:231]
    ds_read_b64_tr_b16 v[34:35], v12 offset:2048
    v_mfma_f32_16x16x32_bf16 v[196:199], v[40:43], a[104:107], v[196:199]
    buffer_load_dword v243, v238, s[24:27], s71 offen sc1
    v_mfma_f32_16x16x32_bf16 v[204:207], v[40:43], a[108:111], v[204:207]
    v_mfma_f32_16x16x32_bf16 v[52:55], v[40:43], a[112:115], v[52:55]
    s_waitcnt lgkmcnt(2)
    v_mfma_f32_16x16x32_bf16 v[224:227], v[44:47], a[116:119], v[224:227]
    ds_read_b64_tr_b16 v[36:37], v13 offset:0
    v_mfma_f32_16x16x32_bf16 v[228:231], v[44:47], a[120:123], v[228:231]
    s_add_u32 s60, s61, 98304
    ds_read_b64_tr_b16 v[38:39], v13 offset:2048
    s_add_u32 m0, s59, 20480
    v_mfma_f32_16x16x32_bf16 v[196:199], v[44:47], a[124:127], v[196:199]
    buffer_load_dwordx4 v4, s[20:23], s60 offen lds
    v_mfma_f32_16x16x32_bf16 v[204:207], v[44:47], a[128:131], v[204:207]
    s_add_u32 m0, s59, 21504
    v_mfma_f32_16x16x32_bf16 v[52:55], v[44:47], a[132:135], v[52:55]
    s_waitcnt lgkmcnt(2)
    buffer_load_dwordx4 v5, s[20:23], s60 offen lds
    v_mfma_f32_16x16x32_bf16 v[224:227], v[32:35], v[128:131], v[224:227]
    ds_read_b64_tr_b16 v[40:41], v14 offset:0
    v_mfma_f32_16x16x32_bf16 v[228:231], v[32:35], v[136:139], v[228:231]
    s_add_u32 m0, s59, 22528
    ds_read_b64_tr_b16 v[42:43], v14 offset:2048
    v_mfma_f32_16x16x32_bf16 v[196:199], v[32:35], v[144:147], v[196:199]
    buffer_load_dwordx4 v6, s[20:23], s60 offen lds
    v_mfma_f32_16x16x32_bf16 v[204:207], v[32:35], v[152:155], v[204:207]
    s_add_u32 m0, s59, 23552
    v_mfma_f32_16x16x32_bf16 v[52:55], v[32:35], v[160:163], v[52:55]
    buffer_load_dwordx4 v7, s[20:23], s60 offen lds
    s_waitcnt lgkmcnt(2)
    s_waitcnt vmcnt(6)
    s_mov_b64 exec, 3
    buffer_store_dword v249, v248, s[24:27], s74 offen sc1
    s_mov_b64 exec, -1
    v_mfma_f32_16x16x32_bf16 v[224:227], v[36:39], a[136:139], v[224:227]
    ds_read_b64_tr_b16 v[44:45], v15 offset:0
    v_mfma_f32_16x16x32_bf16 v[228:231], v[36:39], a[140:143], v[228:231]
    s_lshr_b32 s97, s54, 2
    ds_read_b64_tr_b16 v[46:47], v15 offset:2048
    s_add_u32 s97, s97, 7
    v_mfma_f32_16x16x32_bf16 v[196:199], v[36:39], a[144:147], v[196:199]
    s_add_u32 s98, s97, s56
    s_and_b32 s98, s98, 7
    s_lshl_b32 s99, s58, 3
    v_mfma_f32_16x16x32_bf16 v[204:207], v[36:39], a[148:151], v[204:207]
    s_add_u32 s98, s98, s99
    s_lshl_b32 s73, s98, 3
    s_add_u32 s73, s73, s97
    v_mfma_f32_16x16x32_bf16 v[52:55], v[36:39], a[152:155], v[52:55]
    s_barrier
    s_waitcnt lgkmcnt(2)
    v_mfma_f32_16x16x32_bf16 v[224:227], v[40:43], a[156:159], v[224:227]
    s_mul_i32 s73, s73, 10240
    ds_read_b64_tr_b16 v[32:33], v12 offset:4096
    s_lshl_b32 s98, s98, 7
    v_mfma_f32_16x16x32_bf16 v[228:231], v[40:43], a[160:163], v[228:231]
    s_lshl_b32 s97, s97, 2
    ds_read_b64_tr_b16 v[34:35], v12 offset:6144
    s_add_u32 s98, s98, s97
    v_mfma_f32_16x16x32_bf16 v[196:199], v[40:43], a[164:167], v[196:199]
    s_add_u32 s74, s98, 33554432
    s_and_b32 s97, s54, 3
    s_mul_i32 s99, s97, 2560
    v_mfma_f32_16x16x32_bf16 v[204:207], v[40:43], a[168:171], v[204:207]
    s_add_u32 s73, s73, s99
    s_lshl_b32 s99, s97, 5
    s_add_u32 s74, s74, s99
    v_mfma_f32_16x16x32_bf16 v[52:55], v[40:43], a[172:175], v[52:55]
    s_waitcnt lgkmcnt(2)
    v_mfma_f32_16x16x32_bf16 v[224:227], v[44:47], a[176:179], v[224:227]
    ds_read_b64_tr_b16 v[36:37], v13 offset:4096
    v_mfma_f32_16x16x32_bf16 v[228:231], v[44:47], a[180:183], v[228:231]
    ds_read_b64_tr_b16 v[38:39], v13 offset:6144
    v_mfma_f32_16x16x32_bf16 v[196:199], v[44:47], a[184:187], v[196:199]
    v_mfma_f32_16x16x32_bf16 v[204:207], v[44:47], a[188:191], v[204:207]
    v_mfma_f32_16x16x32_bf16 v[52:55], v[44:47], a[192:195], v[52:55]
    s_waitcnt lgkmcnt(2)
    v_mfma_f32_16x16x32_bf16 v[224:227], v[32:35], v[168:171], v[224:227]
    ds_read_b64_tr_b16 v[40:41], v14 offset:4096
    v_mfma_f32_16x16x32_bf16 v[228:231], v[32:35], v[176:179], v[228:231]
    ds_read_b64_tr_b16 v[42:43], v14 offset:6144
    v_mfma_f32_16x16x32_bf16 v[196:199], v[32:35], v[184:187], v[196:199]
    v_mfma_f32_16x16x32_bf16 v[204:207], v[32:35], v[192:195], v[204:207]
    v_mfma_f32_16x16x32_bf16 v[52:55], v[32:35], v[200:203], v[52:55]
    s_waitcnt lgkmcnt(2)
    v_mfma_f32_16x16x32_bf16 v[224:227], v[36:39], a[196:199], v[224:227]
    ds_read_b64_tr_b16 v[44:45], v15 offset:4096
    v_mfma_f32_16x16x32_bf16 v[228:231], v[36:39], a[200:203], v[228:231]
    ds_read_b64_tr_b16 v[46:47], v15 offset:6144
    v_mfma_f32_16x16x32_bf16 v[196:199], v[36:39], a[204:207], v[196:199]
    v_mfma_f32_16x16x32_bf16 v[204:207], v[36:39], a[208:211], v[204:207]
    v_mfma_f32_16x16x32_bf16 v[52:55], v[36:39], a[212:215], v[52:55]
    s_barrier
    s_waitcnt lgkmcnt(2)
    v_mfma_f32_16x16x32_bf16 v[224:227], v[40:43], a[216:219], v[224:227]
    ds_read_b64_tr_b16 v[32:33], v8 offset:8192
    s_waitcnt vmcnt(5)
    v_cmp_ne_u32 vcc, 0, v243
    s_nop 0
    s_and_b32 s3, vcc_lo, 30
    s_cmp_eq_u32 s3, 30
    s_cbranch_scc1 L_w0_ok
    s_mov_b32 s79, 0
L_w0:
    buffer_load_dword v243, v238, s[24:27], s71 offen sc1
    s_waitcnt vmcnt(0)
    v_cmp_ne_u32 vcc, 0, v243
    s_nop 0
    s_and_b32 s3, vcc_lo, 30
    s_cmp_eq_u32 s3, 30
    s_cbranch_scc1 L_w0_ok
    s_add_u32 s79, s79, 1
    s_cmp_lt_u32 s79, 0x40000
    s_cbranch_scc1 L_w0
L_w0_ok:
    v_mfma_f32_16x16x32_bf16 v[228:231], v[40:43], a[220:223], v[228:231]
    s_add_u32 s65, s72, 10240
    ds_read_b64_tr_b16 v[34:35], v8 offset:10240
    v_mfma_f32_16x16x32_bf16 v[196:199], v[40:43], a[224:227], v[196:199]
    buffer_load_dwordx4 v[172:175], v29, s[24:27], s65 offen sc1
    v_mfma_f32_16x16x32_bf16 v[204:207], v[40:43], a[228:231], v[204:207]
    v_mfma_f32_16x16x32_bf16 v[52:55], v[40:43], a[232:235], v[52:55]
    s_waitcnt lgkmcnt(2)
    v_mfma_f32_16x16x32_bf16 v[224:227], v[44:47], a[236:239], v[224:227]
    ds_read_b64_tr_b16 v[36:37], v9 offset:8192
    v_mfma_f32_16x16x32_bf16 v[228:231], v[44:47], a[240:243], v[228:231]
    ds_read_b64_tr_b16 v[38:39], v9 offset:10240
    v_mfma_f32_16x16x32_bf16 v[196:199], v[44:47], a[244:247], v[196:199]
    buffer_load_dwordx4 v[180:183], v29, s[24:27], s65 offen offset:1024 sc1
    v_mfma_f32_16x16x32_bf16 v[204:207], v[44:47], a[248:251], v[204:207]
    v_mfma_f32_16x16x32_bf16 v[52:55], v[44:47], a[252:255], v[52:55]
    s_waitcnt lgkmcnt(2)
    v_mfma_f32_16x16x32_bf16 v[60:63], v[32:35], v[48:51], 0
    ds_read_b64_tr_b16 v[40:41], v10 offset:8192
    v_cvt_pk_bf16_f32 v224, v224, v225
    v_mfma_f32_16x16x32_bf16 v[68:71], v[32:35], v[56:59], 0
    ds_read_b64_tr_b16 v[42:43], v10 offset:10240
    v_cvt_pk_bf16_f32 v225, v226, v227
    v_mfma_f32_16x16x32_bf16 v[76:79], v[32:35], v[64:67], 0
    buffer_load_dwordx2 v[100:101], v30, s[24:27], s65 offen offset:2048 sc1
    v_cvt_pk_bf16_f32 v226, v228, v229
    v_cvt_pk_bf16_f32 v227, v230, v231
    v_mfma_f32_16x16x32_bf16 v[84:87], v[32:35], v[72:75], 0
    buffer_store_dwordx4 v[224:227], v29, s[24:27], s73 offen offset:0 sc1
    v_cvt_pk_bf16_f32 v196, v196, v197
    v_mfma_f32_16x16x32_bf16 v[164:167], v[32:35], v[80:83], 0
    s_waitcnt lgkmcnt(2)
    v_cvt_pk_bf16_f32 v197, v198, v199
    v_cvt_pk_bf16_f32 v198, v204, v205
    v_mfma_f32_16x16x32_bf16 v[60:63], v[36:39], a[16:19], v[60:63]
    ds_read_b64_tr_b16 v[44:45], v11 offset:8192
    v_cvt_pk_bf16_f32 v199, v206, v207
    v_mfma_f32_16x16x32_bf16 v[68:71], v[36:39], a[20:23], v[68:71]
    s_add_u32 s65, s72, 20480
    ds_read_b64_tr_b16 v[46:47], v11 offset:10240
    v_mfma_f32_16x16x32_bf16 v[76:79], v[36:39], a[24:27], v[76:79]
    buffer_store_dwordx4 v[196:199], v29, s[24:27], s73 offen offset:1024 sc1
    v_cvt_pk_bf16_f32 v52, v52, v53
    buffer_load_dwordx4 v[188:191], v29, s[24:27], s65 offen sc1
    v_mfma_f32_16x16x32_bf16 v[84:87], v[36:39], a[28:31], v[84:87]
    v_cvt_pk_bf16_f32 v53, v54, v55
    buffer_store_dwordx2 v[52:53], v30, s[24:27], s73 offen offset:2048 sc1
    v_mfma_f32_16x16x32_bf16 v[164:167], v[36:39], a[32:35], v[164:167]
    s_barrier
    s_waitcnt lgkmcnt(2)
    v_mfma_f32_16x16x32_bf16 v[60:63], v[40:43], a[36:39], v[60:63]
    ds_read_b64_tr_b16 v[32:33], v8 offset:12288
    v_mfma_f32_16x16x32_bf16 v[68:71], v[40:43], a[40:43], v[68:71]
    ds_read_b64_tr_b16 v[34:35], v8 offset:14336
    v_mfma_f32_16x16x32_bf16 v[76:79], v[40:43], a[44:47], v[76:79]
    buffer_load_dwordx4 v[92:95], v29, s[24:27], s65 offen offset:1024 sc1
    v_mfma_f32_16x16x32_bf16 v[84:87], v[40:43], a[48:51], v[84:87]
    v_mfma_f32_16x16x32_bf16 v[164:167], v[40:43], a[52:55], v[164:167]
    s_waitcnt lgkmcnt(2)
    v_mfma_f32_16x16x32_bf16 v[60:63], v[44:47], a[56:59], v[60:63]
    ds_read_b64_tr_b16 v[36:37], v9 offset:12288
    v_mfma_f32_16x16x32_bf16 v[68:71], v[44:47], a[60:63], v[68:71]
    ds_read_b64_tr_b16 v[38:39], v9 offset:14336
    v_mfma_f32_16x16x32_bf16 v[76:79], v[44:47], a[64:67], v[76:79]
    buffer_load_dwordx2 v[102:103], v30, s[24:27], s65 offen offset:2048 sc1
    v_mfma_f32_16x16x32_bf16 v[84:87], v[44:47], a[68:71], v[84:87]
    v_mfma_f32_16x16x32_bf16 v[164:167], v[44:47], a[72:75], v[164:167]
    s_waitcnt lgkmcnt(2)
    v_mfma_f32_16x16x32_bf16 v[60:63], v[32:35], v[88:91], v[60:63]
    ds_read_b64_tr_b16 v[40:41], v10 offset:12288
    v_mfma_f32_16x16x32_bf16 v[68:71], v[32:35], v[96:99], v[68:71]
    s_add_u32 s65, s72, 30720
    ds_read_b64_tr_b16 v[42:43], v10 offset:14336
    v_mfma_f32_16x16x32_bf16 v[76:79], v[32:35], v[104:107], v[76:79]
    buffer_load_dwordx4 v[108:111], v29, s[24:27], s65 offen sc1
    v_mfma_f32_16x16x32_bf16 v[84:87], v[32:35], v[112:115], v[84:87]
    v_mfma_f32_16x16x32_bf16 v[164:167], v[32:35], v[120:123], v[164:167]
    s_waitcnt lgkmcnt(2)
    v_mfma_f32_16x16x32_bf16 v[60:63], v[36:39], a[76:79], v[60:63]
    ds_read_b64_tr_b16 v[44:45], v11 offset:12288
    v_mfma_f32_16x16x32_bf16 v[68:71], v[36:39], a[80:83], v[68:71]
    ds_read_b64_tr_b16 v[46:47], v11 offset:14336
    v_mfma_f32_16x16x32_bf16 v[76:79], v[36:39], a[84:87], v[76:79]
    buffer_load_dwordx4 v[116:119], v29, s[24:27], s65 offen offset:1024 sc1
    v_mfma_f32_16x16x32_bf16 v[84:87], v[36:39], a[88:91], v[84:87]
    v_mfma_f32_16x16x32_bf16 v[164:167], v[36:39], a[92:95], v[164:167]
    s_barrier
    s_waitcnt lgkmcnt(2)
    v_mfma_f32_16x16x32_bf16 v[60:63], v[40:43], a[96:99], v[60:63]
    ds_read_b64_tr_b16 v[32:33], v8 offset:16384
    v_mfma_f32_16x16x32_bf16 v[68:71], v[40:43], a[100:103], v[68:71]
    ds_read_b64_tr_b16 v[34:35], v8 offset:18432
    v_mfma_f32_16x16x32_bf16 v[76:79], v[40:43], a[104:107], v[76:79]
    buffer_load_dwordx2 v[140:141], v30, s[24:27], s65 offen offset:2048 sc1
    v_mfma_f32_16x16x32_bf16 v[84:87], v[40:43], a[108:111], v[84:87]
    v_mfma_f32_16x16x32_bf16 v[164:167], v[40:43], a[112:115], v[164:167]
    s_waitcnt lgkmcnt(2)
    v_mfma_f32_16x16x32_bf16 v[60:63], v[44:47], a[116:119], v[60:63]
    ds_read_b64_tr_b16 v[36:37], v9 offset:16384
    v_mfma_f32_16x16x32_bf16 v[68:71], v[44:47], a[120:123], v[68:71]
    s_add_u32 s65, s72, 40960
    ds_read_b64_tr_b16 v[38:39], v9 offset:18432
    v_mfma_f32_16x16x32_bf16 v[76:79], v[44:47], a[124:127], v[76:79]
    buffer_load_dwordx4 v[124:127], v29, s[24:27], s65 offen sc1
    v_mfma_f32_16x16x32_bf16 v[84:87], v[44:47], a[128:131], v[84:87]
    v_mfma_f32_16x16x32_bf16 v[164:167], v[44:47], a[132:135], v[164:167]
    s_waitcnt lgkmcnt(2)
    v_mfma_f32_16x16x32_bf16 v[60:63], v[32:35], v[128:131], v[60:63]
    ds_read_b64_tr_b16 v[40:41], v10 offset:16384
    v_mfma_f32_16x16x32_bf16 v[68:71], v[32:35], v[136:139], v[68:71]
    ds_read_b64_tr_b16 v[42:43], v10 offset:18432
    v_mfma_f32_16x16x32_bf16 v[76:79], v[32:35], v[144:147], v[76:79]
    buffer_load_dwordx4 v[132:135], v29, s[24:27], s65 offen offset:1024 sc1
    v_mfma_f32_16x16x32_bf16 v[84:87], v[32:35], v[152:155], v[84:87]
    v_mfma_f32_16x16x32_bf16 v[164:167], v[32:35], v[160:163], v[164:167]
    s_waitcnt lgkmcnt(2)
    v_mfma_f32_16x16x32_bf16 v[60:63], v[36:39], a[136:139], v[60:63]
    ds_read_b64_tr_b16 v[44:45], v11 offset:16384
    v_mfma_f32_16x16x32_bf16 v[68:71], v[36:39], a[140:143], v[68:71]
    ds_read_b64_tr_b16 v[46:47], v11 offset:18432
    v_mfma_f32_16x16x32_bf16 v[76:79], v[36:39], a[144:147], v[76:79]
    buffer_load_dwordx2 v[142:143], v30, s[24:27], s65 offen offset:2048 sc1
    v_mfma_f32_16x16x32_bf16 v[84:87], v[36:39], a[148:151], v[84:87]
    v_mfma_f32_16x16x32_bf16 v[164:167], v[36:39], a[152:155], v[164:167]
    s_waitcnt vmcnt(16)
    s_barrier
    s_waitcnt lgkmcnt(2)
    v_mfma_f32_16x16x32_bf16 v[60:63], v[40:43], a[156:159], v[60:63]
    ds_read_b64_tr_b16 v[32:33], v8 offset:20480
    v_mfma_f32_16x16x32_bf16 v[68:71], v[40:43], a[160:163], v[68:71]
    ds_read_b64_tr_b16 v[34:35], v8 offset:22528
    v_mfma_f32_16x16x32_bf16 v[76:79], v[40:43], a[164:167], v[76:79]
    buffer_load_dword v243, v238, s[24:27], s71 offen sc1
    v_mfma_f32_16x16x32_bf16 v[84:87], v[40:43], a[168:171], v[84:87]
    v_mfma_f32_16x16x32_bf16 v[164:167], v[40:43], a[172:175], v[164:167]
    s_waitcnt lgkmcnt(2)
    v_mfma_f32_16x16x32_bf16 v[60:63], v[44:47], a[176:179], v[60:63]
    ds_read_b64_tr_b16 v[36:37], v9 offset:20480
    v_mfma_f32_16x16x32_bf16 v[68:71], v[44:47], a[180:183], v[68:71]
    ds_read_b64_tr_b16 v[38:39], v9 offset:22528
    v_mfma_f32_16x16x32_bf16 v[76:79], v[44:47], a[184:187], v[76:79]
    v_mfma_f32_16x16x32_bf16 v[84:87], v[44:47], a[188:191], v[84:87]
    v_mfma_f32_16x16x32_bf16 v[164:167], v[44:47], a[192:195], v[164:167]
    s_waitcnt lgkmcnt(2)
    v_mfma_f32_16x16x32_bf16 v[60:63], v[32:35], v[168:171], v[60:63]
    ds_read_b64_tr_b16 v[40:41], v10 offset:20480
    v_mfma_f32_16x16x32_bf16 v[68:71], v[32:35], v[176:179], v[68:71]
    ds_read_b64_tr_b16 v[42:43], v10 offset:22528
    v_mfma_f32_16x16x32_bf16 v[76:79], v[32:35], v[184:187], v[76:79]
    v_mfma_f32_16x16x32_bf16 v[84:87], v[32:35], v[192:195], v[84:87]
    v_mfma_f32_16x16x32_bf16 v[164:167], v[32:35], v[200:203], v[164:167]
    s_waitcnt lgkmcnt(2)
    v_mfma_f32_16x16x32_bf16 v[60:63], v[36:39], a[196:199], v[60:63]
    ds_read_b64_tr_b16 v[44:45], v11 offset:20480
    s_waitcnt vmcnt(9)
    s_mov_b64 exec, 1
    buffer_store_dword v249, v248, s[24:27], s74 offen sc1
    s_mov_b64 exec, -1
    v_mfma_f32_16x16x32_bf16 v[68:71], v[36:39], a[200:203], v[68:71]
    ds_read_b64_tr_b16 v[46:47], v11 offset:22528
    v_mfma_f32_16x16x32_bf16 v[76:79], v[36:39], a[204:207], v[76:79]
    v_mfma_f32_16x16x32_bf16 v[84:87], v[36:39], a[208:211], v[84:87]
    v_mfma_f32_16x16x32_bf16 v[164:167], v[36:39], a[212:215], v[164:167]
    s_waitcnt lgkmcnt(2)
    v_mfma_f32_16x16x32_bf16 v[60:63], v[40:43], a[216:219], v[60:63]
    v_mfma_f32_16x16x32_bf16 v[68:71], v[40:43], a[220:223], v[68:71]
    v_mfma_f32_16x16x32_bf16 v[76:79], v[40:43], a[224:227], v[76:79]
    v_mfma_f32_16x16x32_bf16 v[84:87], v[40:43], a[228:231], v[84:87]
    v_mfma_f32_16x16x32_bf16 v[164:167], v[40:43], a[232:235], v[164:167]
    s_waitcnt lgkmcnt(0)
    v_mfma_f32_16x16x32_bf16 v[60:63], v[44:47], a[236:239], v[60:63]
    v_mfma_f32_16x16x32_bf16 v[68:71], v[44:47], a[240:243], v[68:71]
    v_mfma_f32_16x16x32_bf16 v[76:79], v[44:47], a[244:247], v[76:79]
    v_mfma_f32_16x16x32_bf16 v[84:87], v[44:47], a[248:251], v[84:87]
    v_mfma_f32_16x16x32_bf16 v[164:167], v[44:47], a[252:255], v[164:167]
    s_waitcnt vmcnt(1)
    v_cmp_ne_u32 vcc, 0, v243
    s_nop 0
    s_and_b32 s3, vcc_lo, 96
    s_cmp_eq_u32 s3, 96
    s_cbranch_scc1 L_w1_ok
    s_mov_b32 s79, 0
L_w1:
    buffer_load_dword v243, v238, s[24:27], s71 offen sc1
    s_waitcnt vmcnt(0)
    v_cmp_ne_u32 vcc, 0, v243
    s_nop 0
    s_and_b32 s3, vcc_lo, 96
    s_cmp_eq_u32 s3, 96
    s_cbranch_scc1 L_w1_ok
    s_add_u32 s79, s79, 1
    s_cmp_lt_u32 s79, 0x40000
    s_cbranch_scc1 L_w1
L_w1_ok:
    s_add_u32 s65, s72, 51200
    buffer_load_dwordx4 v[148:151], v29, s[24:27], s65 offen sc1
    buffer_load_dwordx4 v[156:159], v29, s[24:27], s65 offen offset:1024 sc1
    buffer_load_dwordx2 v[216:217], v30, s[24:27], s65 offen offset:2048 sc1
    s_add_u32 s65, s72, 61440
    buffer_load_dwordx4 v[208:211], v29, s[24:27], s65 offen sc1
    buffer_load_dwordx4 v[212:215], v29, s[24:27], s65 offen offset:1024 sc1
    buffer_load_dwordx2 v[218:219], v30, s[24:27], s65 offen offset:2048 sc1
    v_cmp_ne_u32 vcc, 0, v243
    s_nop 0
    s_and_b32 s3, vcc_lo, 128
    s_cmp_eq_u32 s3, 128
    s_cbranch_scc1 L_w2_ok
    s_mov_b32 s79, 0
L_w2:
    buffer_load_dword v243, v238, s[24:27], s71 offen sc1
    s_waitcnt vmcnt(0)
    v_cmp_ne_u32 vcc, 0, v243
    s_nop 0
    s_and_b32 s3, vcc_lo, 128
    s_cmp_eq_u32 s3, 128
    s_cbranch_scc1 L_w2_ok
    s_add_u32 s79, s79, 1
    s_cmp_lt_u32 s79, 0x40000
    s_cbranch_scc1 L_w2
L_w2_ok:
    s_add_u32 s65, s72, 71680
    buffer_load_dwordx4 v[220:223], v29, s[24:27], s65 offen sc1
    buffer_load_dwordx4 v[224:227], v29, s[24:27], s65 offen offset:1024 sc1
    buffer_load_dwordx2 v[228:229], v30, s[24:27], s65 offen offset:2048 sc1
    v_mfma_f32_16x16x16_bf16 v[60:63], v[236:237], v[172:173], v[60:63]
    v_mfma_f32_16x16x16_bf16 v[68:71], v[236:237], v[174:175], v[68:71]
    v_mfma_f32_16x16x16_bf16 v[76:79], v[236:237], v[180:181], v[76:79]
    v_mfma_f32_16x16x16_bf16 v[84:87], v[236:237], v[182:183], v[84:87]
    v_mfma_f32_16x16x16_bf16 v[164:167], v[236:237], v[100:101], v[164:167]
    v_mfma_f32_16x16x16_bf16 v[60:63], v[236:237], v[188:189], v[60:63]
    v_mfma_f32_16x16x16_bf16 v[68:71], v[236:237], v[190:191], v[68:71]
    v_mfma_f32_16x16x16_bf16 v[76:79], v[236:237], v[92:93], v[76:79]
    v_mfma_f32_16x16x16_bf16 v[84:87], v[236:237], v[94:95], v[84:87]
    v_mfma_f32_16x16x16_bf16 v[164:167], v[236:237], v[102:103], v[164:167]
    v_mfma_f32_16x16x16_bf16 v[60:63], v[236:237], v[108:109], v[60:63]
    v_mfma_f32_16x16x16_bf16 v[68:71], v[236:237], v[110:111], v[68:71]
    v_mfma_f32_16x16x16_bf16 v[76:79], v[236:237], v[116:117], v[76:79]
    v_mfma_f32_16x16x16_bf16 v[84:87], v[236:237], v[118:119], v[84:87]
    v_mfma_f32_16x16x16_bf16 v[164:167], v[236:237], v[140:141], v[164:167]
    v_mfma_f32_16x16x16_bf16 v[60:63], v[236:237], v[124:125], v[60:63]
    v_mfma_f32_16x16x16_bf16 v[68:71], v[236:237], v[126:127], v[68:71]
    v_mfma_f32_16x16x16_bf16 v[76:79], v[236:237], v[132:133], v[76:79]
    v_mfma_f32_16x16x16_bf16 v[84:87], v[236:237], v[134:135], v[84:87]
    v_mfma_f32_16x16x16_bf16 v[164:167], v[236:237], v[142:143], v[164:167]
    s_waitcnt vmcnt(6)
    v_mfma_f32_16x16x16_bf16 v[60:63], v[236:237], v[148:149], v[60:63]
    v_mfma_f32_16x16x16_bf16 v[68:71], v[236:237], v[150:151], v[68:71]
    v_mfma_f32_16x16x16_bf16 v[76:79], v[236:237], v[156:157], v[76:79]
    v_mfma_f32_16x16x16_bf16 v[84:87], v[236:237], v[158:159], v[84:87]
    v_mfma_f32_16x16x16_bf16 v[164:167], v[236:237], v[216:217], v[164:167]
    s_waitcnt vmcnt(3)
    v_mfma_f32_16x16x16_bf16 v[60:63], v[236:237], v[208:209], v[60:63]
    v_mfma_f32_16x16x16_bf16 v[68:71], v[236:237], v[210:211], v[68:71]
    v_mfma_f32_16x16x16_bf16 v[76:79], v[236:237], v[212:213], v[76:79]
    v_mfma_f32_16x16x16_bf16 v[84:87], v[236:237], v[214:215], v[84:87]
    v_mfma_f32_16x16x16_bf16 v[164:167], v[236:237], v[218:219], v[164:167]
    s_waitcnt vmcnt(0)
    v_mfma_f32_16x16x16_bf16 v[60:63], v[236:237], v[220:221], v[60:63]
    v_mfma_f32_16x16x16_bf16 v[68:71], v[236:237], v[222:223], v[68:71]
    v_mfma_f32_16x16x16_bf16 v[76:79], v[236:237], v[224:225], v[76:79]
    v_mfma_f32_16x16x16_bf16 v[84:87], v[236:237], v[226:227], v[84:87]
    v_mfma_f32_16x16x16_bf16 v[164:167], v[236:237], v[228:229], v[164:167]
    s_nop 3
    v_cvt_pk_bf16_f32 v60, v60, v61
    v_cvt_pk_bf16_f32 v61, v62, v63
    ds_write_b64 v16, v[60:61] offset:24576
    v_cvt_pk_bf16_f32 v68, v68, v69
    v_cvt_pk_bf16_f32 v69, v70, v71
    ds_write_b64 v16, v[68:69] offset:26624
    v_cvt_pk_bf16_f32 v76, v76, v77
    v_cvt_pk_bf16_f32 v77, v78, v79
    ds_write_b64 v16, v[76:77] offset:28672
    v_cvt_pk_bf16_f32 v84, v84, v85
    v_cvt_pk_bf16_f32 v85, v86, v87
    ds_write_b64 v16, v[84:85] offset:30720
    v_cvt_pk_bf16_f32 v164, v164, v165
    v_cvt_pk_bf16_f32 v165, v166, v167
    ds_write_b64 v16, v[164:165] offset:32768
    s_waitcnt lgkmcnt(0)
    s_barrier
    ds_read_b128 v[32:35], v17 offset:24576
    ds_read_b128 v[36:39], v17 offset:28672
    ds_read_b128 v[40:43], v17 offset:32768
    s_add_u32 s3, s47, 65536
    s_waitcnt lgkmcnt(2)
    buffer_store_dwordx4 v[32:35], v18, s[28:31], s47 offen
    s_waitcnt lgkmcnt(1)
    buffer_store_dwordx4 v[36:39], v18, s[28:31], s3 offen
    s_waitcnt lgkmcnt(0)
    buffer_store_dwordx4 v[40:43], v18, s[28:31], s46 offen
L_end:
    s_endpgm
.section .rodata,"a"
.p2align 6
.amdhsa_kernel concat_heads__mha_block_cached__mha_block_cached__near_ridge_kernel
  .amdhsa_next_free_vgpr 512
  .amdhsa_next_free_sgpr 102
  .amdhsa_accum_offset 256
  .amdhsa_group_segment_fixed_size 0
  .amdhsa_kernarg_size 104
  .amdhsa_user_sgpr_count 2
  .amdhsa_user_sgpr_kernarg_segment_ptr 1
  .amdhsa_system_sgpr_workgroup_id_x 1
.end_amdhsa_kernel
```
